```python
import torch

def _softmax(x, axis=-1):
    return torch.softmax(x, dim=axis)
def _gelu(x):
    return torch.nn.functional.gelu(x, approximate="tanh")
def _silu(x):
    return torch.nn.functional.silu(x)
def _sigmoid(x):
    return torch.sigmoid(x)
def _layernorm(x, axis=-1, eps=1e-5):
    m = x.mean(dim=axis, keepdim=True)
    v = x.var(dim=axis, keepdim=True, unbiased=False)
    return (x - m) / torch.sqrt(v + eps)
def _scatter_add(tgt, idx, src, axis=0):
    return tgt.clone().index_add_(axis, idx, src)
def _segment_sum(src, seg, n):
    out = torch.zeros((n,) + src.shape[1:], dtype=src.dtype)
    return out.index_add_(0, seg, src)
def _pad(x, pw):
    flat = tuple(v for pair in reversed(pw) for v in pair)
    return torch.nn.functional.pad(x, flat)

kernel_name = 'concat_heads__softmax_full_mha__ssm_conv_h3__prompt'

def setup_inputs():

    _w = (lambda a: (lambda t: t.to(torch.bfloat16) if t.is_floating_point() else t)(torch.as_tensor(a)))
    def _A_setup():
        B, S, D = 1, 2048, 640
        return {
            "x": _w((lambda *s: torch.randn(*s, dtype=torch.bfloat16) * 0.2)(B, S, D)),
            "wqkv": _w((lambda *s: torch.randn(*s, dtype=torch.bfloat16) * 0.2)(D, 3 * D)),
            "wo": _w((lambda *s: torch.randn(*s, dtype=torch.bfloat16) * 0.05)(D, D)),
        }
    _A_in = _A_setup()

    def _B_setup():
        B, S, D = 1, 2048, 640
        ks = 4
        return {
            "q": _w((lambda *s: torch.randn(*s, dtype=torch.bfloat16) * 0.05)(B, S, D)),
            "k": _w((lambda *s: torch.randn(*s, dtype=torch.bfloat16) * 0.4)(B, S, D)),
            "v": _w((lambda *s: torch.randn(*s, dtype=torch.bfloat16) * 0.4)(B, S, D)),
            "shift_k": _w((lambda *s: torch.randn(*s, dtype=torch.bfloat16) * 0.4)(D, ks) * 0.5),
            "ssm_k": _w((lambda *s: torch.randn(*s, dtype=torch.bfloat16) * 1.6)(D, S) * (1.0 / S ** 0.5)),
            "ssm_D": _w((lambda *s: torch.randn(*s, dtype=torch.bfloat16) * 0.4)(D)),
        }
    _B_in = _B_setup()

    return {
        "A_x": _A_in["x"],
        "A_wqkv": _A_in["wqkv"],
        "A_wo": _A_in["wo"],
        "B_q": _B_in["q"],
        "B_k": _B_in["k"],
        "B_v": _B_in["v"],
        "B_shift_k": _B_in["shift_k"],
        "B_ssm_k": _B_in["ssm_k"],
        "B_ssm_D": _B_in["ssm_D"],
    }

def reference(A_x, A_wqkv, A_wo, B_q, B_k, B_v, B_shift_k, B_ssm_k, B_ssm_D):
    def _A_ref(x, wqkv, wo):
        B, S, D = x.shape
        H = 32; Dh = D // H
        qkv = (lambda x, *d: x.permute(*d))((x @ wqkv).reshape(B, S, 3, H, Dh), 2, 0, 3, 1, 4)
        q, k, v = qkv[0], qkv[1], qkv[2]
        scale = Dh ** -0.5
        scores = torch.einsum("bhqd,bhkd->bhqk", q, k) * scale
        p = _softmax(scores, axis=-1)
        o = torch.einsum("bhqk,bhkd->bhqd", p, v)
        return (lambda x, *d: x.permute(*d))(o, 0, 2, 1, 3).reshape(B, S, D) @ wo

    def _B_ref(q, k, v, shift_k, ssm_k, ssm_D):
        B, S, D = q.shape
        ks = shift_k.shape[-1]
        k_pad = _pad(k, ((0, 0), (ks - 1, 0), (0, 0)))
        k_shift = torch.zeros_like(k)
        for t in range(ks):
            k_shift = k_shift + k_pad[:, t:t + S, :] * shift_k[:, ks - 1 - t][None, None, :]
        kv = k_shift * v
        L = 2 * S
        kv_pad = _pad(kv, ((0, 0), (0, S), (0, 0)))
        kf_pad = _pad(ssm_k, ((0, 0), (0, S)))
        kv_f = (lambda x, axes=(-2,-1): torch.fft.rfft2(x.float(), dim=axes))(kv_pad[:, None, :, :], axes=(1, 2))
        kf_f = (lambda x, axes=(-2,-1): torch.fft.rfft2(x.float(), dim=axes))(kf_pad[:, None, :], axes=(1, 2))
        kf_f = (lambda x, *d: x.permute(*d))(kf_f, 1, 2, 0)
        y_f = kv_f * kf_f[None, :, :, :]
        y = (lambda x, s, axes=(-2,-1): torch.fft.irfft2(x, s=s, dim=axes).to(torch.bfloat16))(y_f, (1, L), axes=(1, 2))[:, 0, :S, :]
        y = y + kv * ssm_D[None, None, :]
        return q * y

    a = _A_ref(A_x, A_wqkv, A_wo)
    b = _B_ref(B_q, B_k, B_v, B_shift_k, B_ssm_k, B_ssm_D)
    return torch.concatenate([a, b], axis=-1)
```

```asm
; @launch grid=(256,1,1) block=(512,1,1) lds=163840
.amdgcn_target "amdgcn-amd-amdhsa--gfx950"
.text
.globl concat_heads__softmax_full_mha__ssm_conv_h3__prompt_kernel
.p2align 8
.type concat_heads__softmax_full_mha__ssm_conv_h3__prompt_kernel,@function
concat_heads__softmax_full_mha__ssm_conv_h3__prompt_kernel:

    s_cmp_ge_u32 s2, 256
    s_cbranch_scc1 L_exit
    s_load_dwordx16 s[64:79], s[0:1], 0
    s_load_dwordx8 s[80:87], s[0:1], 64
    v_and_b32 v1, 63, v0
    v_lshrrev_b32 v2, 6, v0
    s_nop 0
    v_readfirstlane_b32 s8, v2
    v_mov_b32 v240, 0x7ff00000
    s_bfe_u32 s33, s2, 0x20001
    s_lshl_b32 s33, s33, 2
    s_bfe_u32 s34, s2, 0x20003
    s_add_u32 s33, s33, s34
    s_and_b32 s32, s2, 1
    s_lshl_b32 s32, s32, 3
    s_lshr_b32 s34, s2, 5
    s_add_u32 s32, s32, s34
    s_and_b32 s43, s2, 7
    s_lshl_b32 s43, s43, 2
    s_bfe_u32 s34, s2, 0x20003
    s_add_u32 s43, s43, s34
    s_lshr_b32 s44, s2, 5
    s_sub_u32 s41, s8, 4
    s_cmp_ge_u32 s32, 15
    s_cselect_b32 s37, 0x7ff00000, 0
    v_bfe_u32 v4, v1, 2, 2
    v_xor_b32 v4, s41, v4
    v_and_b32 v5, 3, v1
    v_xor_b32 v5, v5, v4
    v_bfe_u32 v6, v1, 4, 1
    v_lshl_add_u32 v5, v6, 2, v5
    v_lshrrev_b32 v6, 5, v1
    v_lshl_add_u32 v6, v4, 1, v6
    s_lshl_b32 s35, s33, 7
    s_lshl_b32 s36, s41, 3
    s_add_u32 s35, s35, s36
    v_add_u32 v6, s35, v6
    v_mul_u32_u24 v6, 1280, v6
    v_lshl_add_u32 v12, v5, 4, v6
    v_add_u32 v12, s37, v12
    v_lshrrev_b32 v4, 4, v1
    v_and_b32 v5, 15, v1
    v_lshlrev_b32 v6, 2, v4
    v_xor_b32 v5, v5, v6
    v_lshlrev_b32 v13, 4, v5
    s_lshl_b32 s35, s32, 8
    v_add_u32 v13, s35, v13
    s_lshl_b32 s35, s41, 2
    v_add_u32 v4, s35, v4
    v_mul_u32_u24 v4, 3840, v4
    v_add_u32 v13, v13, v4
    v_add_u32 v13, s37, v13
    s_lshl_b32 s40, s41, 10
    s_lshl_b32 s34, s43, 6
    s_sub_u32 s34, s34, 4
    s_mul_i32 s34, s34, 1280
    s_mul_i32 s35, s44, 160
    s_add_u32 s42, s34, s35
    s_add_u32 s34, s8, 0
    s_min_u32 s34, s34, 10
    s_lshl_b32 s35, s34, 6
    v_add_u32 v4, s35, v1
    v_mul_u32_u24 v5, 6554, v4
    v_lshrrev_b32 v5, 16, v5
    v_mul_u32_u24 v7, 10, v5
    v_sub_u32 v6, v4, v7
    v_mul_u32_u24 v5, 1280, v5
    v_lshl_add_u32 v5, v6, 4, v5
    v_add_u32 v128, s42, v5
    s_add_u32 s34, s8, 8
    s_min_u32 s34, s34, 10
    s_lshl_b32 s35, s34, 6
    v_add_u32 v4, s35, v1
    v_mul_u32_u24 v5, 6554, v4
    v_lshrrev_b32 v5, 16, v5
    v_mul_u32_u24 v7, 10, v5
    v_sub_u32 v6, v4, v7
    v_mul_u32_u24 v5, 1280, v5
    v_lshl_add_u32 v5, v6, 4, v5
    v_add_u32 v129, s42, v5
    v_lshrrev_b32 v8, 4, v1
    v_and_b32 v9, 3, v1
    v_and_b32 v10, 15, v1
    s_add_u32 s34, s8, 0
    s_min_u32 s36, s34, 9
    s_lshl_b32 s35, s36, 10
    s_add_u32 s35, s35, 153600
    v_lshl_add_u32 v4, v10, 2, v8
    v_lshlrev_b32 v138, 4, v4
    v_add_u32 v138, s35, v138
    s_and_b32 s45, s36, 1
    s_lshl_b32 s45, s45, 2
    s_lshr_b32 s36, s36, 1
    s_lshl_b32 s36, s36, 4
    s_mul_i32 s34, s44, 80
    s_add_u32 s34, s34, s36
    v_add_u32 v4, s34, v10
    v_lshlrev_b32 v130, 3, v4
    v_add_u32 v5, s45, v8
    v_bfe_u32 v4, v1, 2, 2
    v_lshl_add_u32 v4, v5, 3, v4
    v_mul_u32_u24 v136, 160, v4
    v_lshl_add_u32 v136, v9, 3, v136
    s_lshl_b32 s36, s36, 1
    s_add_u32 s36, s36, 131072
    v_add_u32 v136, s36, v136
    s_add_u32 s34, s8, 8
    s_min_u32 s36, s34, 9
    s_lshl_b32 s35, s36, 10
    s_add_u32 s35, s35, 153600
    v_lshl_add_u32 v4, v10, 2, v8
    v_lshlrev_b32 v139, 4, v4
    v_add_u32 v139, s35, v139
    s_and_b32 s45, s36, 1
    s_lshl_b32 s45, s45, 2
    s_lshr_b32 s36, s36, 1
    s_lshl_b32 s36, s36, 4
    s_mul_i32 s34, s44, 80
    s_add_u32 s34, s34, s36
    v_add_u32 v4, s34, v10
    v_lshlrev_b32 v131, 3, v4
    v_add_u32 v5, s45, v8
    v_bfe_u32 v4, v1, 2, 2
    v_lshl_add_u32 v4, v5, 3, v4
    v_mul_u32_u24 v137, 160, v4
    v_lshl_add_u32 v137, v9, 3, v137
    s_lshl_b32 s36, s36, 1
    s_add_u32 s36, s36, 131072
    v_add_u32 v137, s36, v137
    s_waitcnt lgkmcnt(0)
    s_mov_b32 s4, s86
    s_and_b32 s5, s87, 0xffff
    s_mov_b32 s6, 268435456
    s_mov_b32 s7, 0x20000
    s_xor_b32 s92, s2, 225
    s_or_b32 s92, s92, s8
    s_cmp_lg_u32 s92, 0
    s_cbranch_scc1 L_noinit_1
    v_lshlrev_b32 v2, 8, v1
    v_mov_b32 v3, 0
    s_mov_b32 s92, 50331648
    buffer_store_dword v3, v2, s[4:7], s92 offen sc1
    s_waitcnt vmcnt(0)
    v_mov_b32 v2, 0
    v_mov_b32 v3, 1
    global_store_dword v2, v3, s[84:85] offset:128 sc1
    s_waitcnt vmcnt(0)
L_noinit_1:
    s_mov_b32 s20, s72
    s_and_b32 s21, s73, 0xffff
    s_mov_b32 s22, 2621440
    s_mov_b32 s23, 0x20000
    s_mov_b32 s24, s74
    s_and_b32 s25, s75, 0xffff
    s_mov_b32 s26, 2621440
    s_mov_b32 s27, 0x20000
    s_add_u32 s34, s8, 0
    s_min_u32 s34, s34, 10
    s_lshl_b32 s34, s34, 10
    s_add_u32 m0, s34, 131072
    s_nop 0
    buffer_load_dwordx4 v128, s[20:23], 0 offen lds
    s_add_u32 m0, s34, 142336
    s_nop 0
    buffer_load_dwordx4 v128, s[24:27], 0 offen lds
    s_add_u32 s34, s8, 8
    s_min_u32 s34, s34, 10
    s_lshl_b32 s34, s34, 10
    s_add_u32 m0, s34, 131072
    s_nop 0
    buffer_load_dwordx4 v129, s[20:23], 0 offen lds
    s_add_u32 m0, s34, 142336
    s_nop 0
    buffer_load_dwordx4 v129, s[24:27], 0 offen lds
    s_mov_b32 s28, s76
    s_and_b32 s29, s77, 0xffff
    s_mov_b32 s30, 5120
    s_mov_b32 s31, 0x20000
    buffer_load_dwordx2 v[132:133], v130, s[28:31], 0 offen
    buffer_load_dwordx2 v[134:135], v131, s[28:31], 0 offen
    s_cmp_lt_u32 s8, 4
    s_cbranch_scc1 L_p1_compute
L_p1_loader:
    s_mov_b32 s12, s64
    s_and_b32 s13, s65, 0xffff
    s_mov_b32 s14, 2621440
    s_mov_b32 s15, 0x20000
    s_mov_b32 s16, s66
    s_and_b32 s17, s67, 0xffff
    s_mov_b32 s18, 2457600
    s_mov_b32 s19, 0x20000
    s_cmp_ge_u32 s32, 15
    s_cbranch_scc1 L_noiss_12
    s_add_u32 m0, s40, 0
    s_mov_b32 s34, 0
    buffer_load_dwordx4 v12, s[12:15], s34 offen lds
    s_add_u32 m0, s40, 16384
    s_mov_b32 s34, 0
    buffer_load_dwordx4 v13, s[16:19], s34 offen lds
    s_add_u32 m0, s40, 4096
    s_mov_b32 s34, 40960
    buffer_load_dwordx4 v12, s[12:15], s34 offen lds
    s_add_u32 m0, s40, 20480
    s_mov_b32 s34, 61440
    buffer_load_dwordx4 v13, s[16:19], s34 offen lds
    s_add_u32 m0, s40, 8192
    s_mov_b32 s34, 81920
    buffer_load_dwordx4 v12, s[12:15], s34 offen lds
    s_add_u32 m0, s40, 24576
    s_mov_b32 s34, 122880
    buffer_load_dwordx4 v13, s[16:19], s34 offen lds
    s_add_u32 m0, s40, 12288
    s_mov_b32 s34, 122880
    buffer_load_dwordx4 v12, s[12:15], s34 offen lds
    s_add_u32 m0, s40, 28672
    s_mov_b32 s34, 184320
    buffer_load_dwordx4 v13, s[16:19], s34 offen lds
L_noiss_12:
    s_cmp_ge_u32 s32, 15
    s_cbranch_scc1 L_noiss_13
    s_add_u32 m0, s40, 32768
    s_mov_b32 s34, 128
    buffer_load_dwordx4 v12, s[12:15], s34 offen lds
    s_add_u32 m0, s40, 49152
    s_mov_b32 s34, 245760
    buffer_load_dwordx4 v13, s[16:19], s34 offen lds
    s_add_u32 m0, s40, 36864
    s_mov_b32 s34, 41088
    buffer_load_dwordx4 v12, s[12:15], s34 offen lds
    s_add_u32 m0, s40, 53248
    s_mov_b32 s34, 307200
    buffer_load_dwordx4 v13, s[16:19], s34 offen lds
    s_add_u32 m0, s40, 40960
    s_mov_b32 s34, 82048
    buffer_load_dwordx4 v12, s[12:15], s34 offen lds
    s_add_u32 m0, s40, 57344
    s_mov_b32 s34, 368640
    buffer_load_dwordx4 v13, s[16:19], s34 offen lds
    s_add_u32 m0, s40, 45056
    s_mov_b32 s34, 123008
    buffer_load_dwordx4 v12, s[12:15], s34 offen lds
    s_add_u32 m0, s40, 61440
    s_mov_b32 s34, 430080
    buffer_load_dwordx4 v13, s[16:19], s34 offen lds
L_noiss_13:
    s_waitcnt vmcnt(16)
    s_cmp_ge_u32 s32, 15
    s_cbranch_scc0 L_spw_14
    s_waitcnt vmcnt(0)
L_spw_14:
    s_barrier
    ds_read_b64_tr_b16 v[140:141], v136 offset:0
    ds_read_b64_tr_b16 v[142:143], v136 offset:640
    ds_read_b64_tr_b16 v[144:145], v136 offset:1280
    ds_read_b64_tr_b16 v[146:147], v136 offset:11904
    ds_read_b64_tr_b16 v[148:149], v136 offset:12544
    v_lshlrev_b32 v170, 16, v132
    v_and_b32 v171, 0xffff0000, v132
    v_lshlrev_b32 v172, 16, v133
    v_and_b32 v173, 0xffff0000, v133
    s_waitcnt lgkmcnt(2)
    v_and_b32 v151, 0xffff0000, v140
    v_lshlrev_b32 v152, 16, v141
    v_and_b32 v153, 0xffff0000, v141
    v_lshlrev_b32 v154, 16, v142
    v_and_b32 v155, 0xffff0000, v142
    v_lshlrev_b32 v156, 16, v143
    v_and_b32 v157, 0xffff0000, v143
    v_lshlrev_b32 v158, 16, v144
    v_and_b32 v159, 0xffff0000, v144
    v_lshlrev_b32 v160, 16, v145
    v_and_b32 v161, 0xffff0000, v145
    v_mul_f32 v174, v173, v151
    v_mul_f32 v175, v173, v152
    v_mul_f32 v176, v173, v153
    v_mul_f32 v177, v173, v154
    v_mul_f32 v178, v173, v155
    v_mul_f32 v179, v173, v156
    v_mul_f32 v180, v173, v157
    v_mul_f32 v181, v173, v158
    v_fmac_f32 v174, v172, v152
    v_fmac_f32 v175, v172, v153
    v_fmac_f32 v176, v172, v154
    v_fmac_f32 v177, v172, v155
    v_fmac_f32 v178, v172, v156
    v_fmac_f32 v179, v172, v157
    v_fmac_f32 v180, v172, v158
    v_fmac_f32 v181, v172, v159
    s_waitcnt lgkmcnt(0)
    v_lshlrev_b32 v162, 16, v146
    v_and_b32 v163, 0xffff0000, v146
    v_lshlrev_b32 v164, 16, v147
    v_and_b32 v165, 0xffff0000, v147
    v_lshlrev_b32 v166, 16, v148
    v_and_b32 v167, 0xffff0000, v148
    v_lshlrev_b32 v168, 16, v149
    v_and_b32 v169, 0xffff0000, v149
    v_fmac_f32 v174, v171, v153
    v_fmac_f32 v175, v171, v154
    v_fmac_f32 v176, v171, v155
    v_fmac_f32 v177, v171, v156
    v_fmac_f32 v178, v171, v157
    v_fmac_f32 v179, v171, v158
    v_fmac_f32 v180, v171, v159
    v_fmac_f32 v181, v171, v160
    v_fmac_f32 v174, v170, v154
    v_fmac_f32 v175, v170, v155
    v_fmac_f32 v176, v170, v156
    v_fmac_f32 v177, v170, v157
    v_fmac_f32 v178, v170, v158
    v_fmac_f32 v179, v170, v159
    v_fmac_f32 v180, v170, v160
    v_fmac_f32 v181, v170, v161
    v_mul_f32 v174, v174, v162
    v_mul_f32 v175, v175, v163
    v_mul_f32 v176, v176, v164
    v_mul_f32 v177, v177, v165
    v_mul_f32 v178, v178, v166
    v_mul_f32 v179, v179, v167
    v_mul_f32 v180, v180, v168
    v_mul_f32 v181, v181, v169
    v_cvt_pk_bf16_f32 v184, v181, v180
    v_cvt_pk_bf16_f32 v185, v179, v178
    v_cvt_pk_bf16_f32 v186, v177, v176
    v_cvt_pk_bf16_f32 v187, v175, v174
    ds_write_b128 v138, v[184:187]
    s_waitcnt vmcnt(8)
    s_waitcnt lgkmcnt(0)
    s_barrier
    v_mov_b32 v15, 0
    global_load_dword v14, v15, s[84:85] offset:128 sc1
    s_cmp_ge_u32 s32, 15
    s_cbranch_scc1 L_noiss_15
    s_add_u32 m0, s40, 65536
    s_mov_b32 s34, 256
    buffer_load_dwordx4 v12, s[12:15], s34 offen lds
    s_add_u32 m0, s40, 81920
    s_mov_b32 s34, 491520
    buffer_load_dwordx4 v13, s[16:19], s34 offen lds
    s_add_u32 m0, s40, 69632
    s_mov_b32 s34, 41216
    buffer_load_dwordx4 v12, s[12:15], s34 offen lds
    s_add_u32 m0, s40, 86016
    s_mov_b32 s34, 552960
    buffer_load_dwordx4 v13, s[16:19], s34 offen lds
    s_add_u32 m0, s40, 73728
    s_mov_b32 s34, 82176
    buffer_load_dwordx4 v12, s[12:15], s34 offen lds
    s_add_u32 m0, s40, 90112
    s_mov_b32 s34, 614400
    buffer_load_dwordx4 v13, s[16:19], s34 offen lds
    s_add_u32 m0, s40, 77824
    s_mov_b32 s34, 123136
    buffer_load_dwordx4 v12, s[12:15], s34 offen lds
    s_add_u32 m0, s40, 94208
    s_mov_b32 s34, 675840
    buffer_load_dwordx4 v13, s[16:19], s34 offen lds
L_noiss_15:
    s_sub_u32 s60, s2, 224
    s_lshr_b32 s60, s60, 1
    s_add_u32 s60, s60, 224
    s_cmp_lt_u32 s2, 224
    s_cselect_b32 s62, s2, s60
    s_cmp_lt_u32 s62, 160
    s_cselect_b32 s60, 3, 2
    s_mul_i32 s56, s62, s60
    s_cselect_b32 s61, 0, 160
    s_add_u32 s56, s56, s61
    s_and_b32 s61, s2, 1
    s_cmp_gt_u32 s2, 224
    s_cselect_b32 s61, s61, 0
    s_cmp_lg_u32 s61, 0
    s_cselect_b32 s60, 0, s60
    s_sub_u32 s61, s8, 4
    s_add_u32 s56, s56, s61
    s_mul_i32 s57, s61, 8960
    s_add_u32 s57, s57, 131072
    s_mul_i32 s63, s61, 9472
    s_add_u32 s63, s63, 65536
    s_mov_b32 s58, 0
    s_cmp_lt_u32 s61, s60
    s_cselect_b32 s59, 1, 0
    s_cmp_lg_u32 s60, 0
    s_cselect_b32 s62, 2, 0
    s_or_b32 s59, s59, s62
    s_sub_u32 s62, s56, s61
    s_min_u32 s60, s56, 639
    s_lshl_b32 s61, s60, 12
    s_load_dword s10, s[78:79], s61
    s_lshr_b32 s60, s60, 1
    s_lshl_b32 s60, s60, 2
    s_load_dword s11, s[80:81], s60
    v_and_b32 v175, 1, v1
    v_mul_u32_u24 v175, 4, v175
    v_add_u32 v175, s62, v175
    v_max_i32 v175, 1, v175
    v_subrev_u32 v175, 1, v175
    v_min_u32 v175, 639, v175
    v_mul_u32_u24 v175, 52429, v175
    v_lshrrev_b32 v175, 22, v175
    v_add_u32 v175, 16, v175
    v_lshlrev_b32 v175, 8, v175
    v_lshlrev_b32 v19, 4, v1
    s_waitcnt vmcnt(9)
    s_barrier
    s_cmp_ge_u32 s32, 15
    s_cbranch_scc1 L_noiss_16
    s_add_u32 m0, s40, 98304
    s_mov_b32 s34, 384
    buffer_load_dwordx4 v12, s[12:15], s34 offen lds
    s_add_u32 m0, s40, 114688
    s_mov_b32 s34, 737280
    buffer_load_dwordx4 v13, s[16:19], s34 offen lds
    s_add_u32 m0, s40, 102400
    s_mov_b32 s34, 41344
    buffer_load_dwordx4 v12, s[12:15], s34 offen lds
    s_add_u32 m0, s40, 118784
    s_mov_b32 s34, 798720
    buffer_load_dwordx4 v13, s[16:19], s34 offen lds
    s_add_u32 m0, s40, 106496
    s_mov_b32 s34, 82304
    buffer_load_dwordx4 v12, s[12:15], s34 offen lds
    s_add_u32 m0, s40, 122880
    s_mov_b32 s34, 860160
    buffer_load_dwordx4 v13, s[16:19], s34 offen lds
    s_add_u32 m0, s40, 110592
    s_mov_b32 s34, 123264
    buffer_load_dwordx4 v12, s[12:15], s34 offen lds
    s_add_u32 m0, s40, 126976
    s_mov_b32 s34, 921600
    buffer_load_dwordx4 v13, s[16:19], s34 offen lds
L_noiss_16:
    s_cmp_ge_u32 s32, 15
    s_cbranch_scc1 L_noiss_17
    s_add_u32 m0, s40, 0
    s_mov_b32 s34, 512
    buffer_load_dwordx4 v12, s[12:15], s34 offen lds
    s_add_u32 m0, s40, 16384
    s_mov_b32 s34, 983040
    buffer_load_dwordx4 v13, s[16:19], s34 offen lds
    s_add_u32 m0, s40, 4096
    s_mov_b32 s34, 41472
    buffer_load_dwordx4 v12, s[12:15], s34 offen lds
    s_add_u32 m0, s40, 20480
    s_mov_b32 s34, 1044480
    buffer_load_dwordx4 v13, s[16:19], s34 offen lds
    s_add_u32 m0, s40, 8192
    s_mov_b32 s34, 82432
    buffer_load_dwordx4 v12, s[12:15], s34 offen lds
    s_add_u32 m0, s40, 24576
    s_mov_b32 s34, 1105920
    buffer_load_dwordx4 v13, s[16:19], s34 offen lds
    s_add_u32 m0, s40, 12288
    s_mov_b32 s34, 123392
    buffer_load_dwordx4 v12, s[12:15], s34 offen lds
    s_add_u32 m0, s40, 28672
    s_mov_b32 s34, 1167360
    buffer_load_dwordx4 v13, s[16:19], s34 offen lds
L_noiss_17:
    s_cmp_eq_u32 s8, 7
    s_cbranch_scc0 L_lz_18
    v_mov_b32 v2, 163776
    v_mov_b32 v3, 0
    ds_write_b32 v2, v3
    ds_write_b32 v2, v3 offset:4
    ds_write_b32 v2, v3 offset:8
    ds_write_b32 v2, v3 offset:12
    ds_write_b32 v2, v3 offset:16
    ds_write_b32 v2, v3 offset:20
    ds_write_b32 v2, v3 offset:24
    s_waitcnt lgkmcnt(0)
L_lz_18:
    s_waitcnt vmcnt(16)
    s_waitcnt vmcnt(24)
    s_cmp_ge_u32 s32, 15
    s_cbranch_scc0 L_spw_19
    s_waitcnt vmcnt(0)
L_spw_19:
    v_readfirstlane_b32 s34, v14
    s_cmp_lg_u32 s34, 0
    s_cbranch_scc1 L_initok_20
    s_mov_b32 s92, 0
    v_mov_b32 v2, 0
L_winit_21:
    global_load_dword v3, v2, s[84:85] offset:128 sc1
    s_waitcnt vmcnt(0)
    v_readfirstlane_b32 s93, v3
    s_add_u32 s92, s92, 1
    s_cmp_lg_u32 s93, 0
    s_cbranch_scc1 L_winitd_22
    s_sleep 2
    s_cmp_lt_u32 s92, 131072
    s_cbranch_scc1 L_winit_21
L_winitd_22:
L_initok_20:
    s_barrier
    s_cmp_ge_u32 s32, 15
    s_cbranch_scc1 L_noiss_23
    s_add_u32 m0, s40, 32768
    s_mov_b32 s34, 640
    buffer_load_dwordx4 v12, s[12:15], s34 offen lds
    s_add_u32 m0, s40, 49152
    s_mov_b32 s34, 1228800
    buffer_load_dwordx4 v13, s[16:19], s34 offen lds
    s_add_u32 m0, s40, 36864
    s_mov_b32 s34, 41600
    buffer_load_dwordx4 v12, s[12:15], s34 offen lds
    s_add_u32 m0, s40, 53248
    s_mov_b32 s34, 1290240
    buffer_load_dwordx4 v13, s[16:19], s34 offen lds
    s_add_u32 m0, s40, 40960
    s_mov_b32 s34, 82560
    buffer_load_dwordx4 v12, s[12:15], s34 offen lds
    s_add_u32 m0, s40, 57344
    s_mov_b32 s34, 1351680
    buffer_load_dwordx4 v13, s[16:19], s34 offen lds
    s_add_u32 m0, s40, 45056
    s_mov_b32 s34, 123520
    buffer_load_dwordx4 v12, s[12:15], s34 offen lds
    s_add_u32 m0, s40, 61440
    s_mov_b32 s34, 1413120
    buffer_load_dwordx4 v13, s[16:19], s34 offen lds
L_noiss_23:
    s_cmp_eq_u32 s8, 7
    s_cbranch_scc0 L_ursig_24
    s_add_u32 s45, s44, 16
    s_lshl_b32 s92, s45, 8
    s_add_u32 s92, s92, 50331648
    v_mov_b32 v2, 0
    v_mov_b32 v3, 1
    s_mov_b64 s[94:95], exec
    s_mov_b64 exec, 1
    buffer_atomic_add v3, v2, s[4:7], s92 offen
    s_mov_b64 exec, s[94:95]
L_ursig_24:
    s_waitcnt vmcnt(16)
    s_barrier
    s_cmp_ge_u32 s32, 15
    s_cbranch_scc1 L_noiss_25
    s_add_u32 m0, s40, 65536
    s_mov_b32 s34, 768
    buffer_load_dwordx4 v12, s[12:15], s34 offen lds
    s_add_u32 m0, s40, 81920
    s_mov_b32 s34, 1474560
    buffer_load_dwordx4 v13, s[16:19], s34 offen lds
    s_add_u32 m0, s40, 69632
    s_mov_b32 s34, 41728
    buffer_load_dwordx4 v12, s[12:15], s34 offen lds
    s_add_u32 m0, s40, 86016
    s_mov_b32 s34, 1536000
    buffer_load_dwordx4 v13, s[16:19], s34 offen lds
    s_add_u32 m0, s40, 73728
    s_mov_b32 s34, 82688
    buffer_load_dwordx4 v12, s[12:15], s34 offen lds
    s_add_u32 m0, s40, 90112
    s_mov_b32 s34, 1597440
    buffer_load_dwordx4 v13, s[16:19], s34 offen lds
    s_add_u32 m0, s40, 77824
    s_mov_b32 s34, 123648
    buffer_load_dwordx4 v12, s[12:15], s34 offen lds
    s_add_u32 m0, s40, 94208
    s_mov_b32 s34, 1658880
    buffer_load_dwordx4 v13, s[16:19], s34 offen lds
L_noiss_25:
    s_bitcmp1_b32 s59, 0
    s_cbranch_scc0 L_noch_26
    s_mov_b32 s36, s78
    s_and_b32 s37, s79, 0xffff
    s_mov_b32 s38, 2621440
    s_mov_b32 s39, 0x20000
    s_lshl_b32 s60, s56, 12
    s_add_u32 m0, s57, 64
    s_add_u32 s61, s60, 0
    buffer_load_dwordx4 v19, s[36:39], s61 offen lds
    s_add_u32 m0, s57, 1088
    s_add_u32 s61, s60, 1024
    buffer_load_dwordx4 v19, s[36:39], s61 offen lds
    s_add_u32 m0, s57, 2112
    s_add_u32 s61, s60, 2048
    buffer_load_dwordx4 v19, s[36:39], s61 offen lds
    s_add_u32 m0, s57, 3136
    s_add_u32 s61, s60, 3072
    buffer_load_dwordx4 v19, s[36:39], s61 offen lds
    s_mov_b64 exec, 0xff
    s_add_u32 m0, s57, 4160
    s_add_u32 s61, s60, 4096
    buffer_load_dwordx4 v19, s[36:39], s61 offen lds
    s_mov_b64 exec, -1
L_noch_26:
    s_waitcnt vmcnt(16)
    s_barrier
    s_cmp_ge_u32 s32, 15
    s_cbranch_scc1 L_noiss_27
    s_add_u32 m0, s40, 98304
    s_mov_b32 s34, 896
    buffer_load_dwordx4 v12, s[12:15], s34 offen lds
    s_add_u32 m0, s40, 114688
    s_mov_b32 s34, 1720320
    buffer_load_dwordx4 v13, s[16:19], s34 offen lds
    s_add_u32 m0, s40, 102400
    s_mov_b32 s34, 41856
    buffer_load_dwordx4 v12, s[12:15], s34 offen lds
    s_add_u32 m0, s40, 118784
    s_mov_b32 s34, 1781760
    buffer_load_dwordx4 v13, s[16:19], s34 offen lds
    s_add_u32 m0, s40, 106496
    s_mov_b32 s34, 82816
    buffer_load_dwordx4 v12, s[12:15], s34 offen lds
    s_add_u32 m0, s40, 122880
    s_mov_b32 s34, 1843200
    buffer_load_dwordx4 v13, s[16:19], s34 offen lds
    s_add_u32 m0, s40, 110592
    s_mov_b32 s34, 123776
    buffer_load_dwordx4 v12, s[12:15], s34 offen lds
    s_add_u32 m0, s40, 126976
    s_mov_b32 s34, 1904640
    buffer_load_dwordx4 v13, s[16:19], s34 offen lds
L_noiss_27:
    s_bitcmp1_b32 s59, 0
    s_cbranch_scc0 L_noch_28
    s_mov_b32 s36, s78
    s_and_b32 s37, s79, 0xffff
    s_mov_b32 s38, 2621440
    s_mov_b32 s39, 0x20000
    s_lshl_b32 s60, s56, 12
    s_add_u32 m0, s57, 4544
    s_add_u32 s61, s60, 4
    buffer_load_dwordx4 v19, s[36:39], s61 offen lds
    s_add_u32 m0, s57, 5568
    s_add_u32 s61, s60, 1028
    buffer_load_dwordx4 v19, s[36:39], s61 offen lds
    s_add_u32 m0, s57, 6592
    s_add_u32 s61, s60, 2052
    buffer_load_dwordx4 v19, s[36:39], s61 offen lds
    s_add_u32 m0, s57, 7616
    s_add_u32 s61, s60, 3076
    buffer_load_dwordx4 v19, s[36:39], s61 offen lds
    s_mov_b64 exec, 0xff
    s_add_u32 m0, s57, 8640
    s_add_u32 s61, s60, 4100
    buffer_load_dwordx4 v19, s[36:39], s61 offen lds
    s_mov_b64 exec, -1
L_noch_28:
    s_waitcnt vmcnt(16)
    s_barrier
    s_cmp_eq_u32 s8, 7
    s_cbranch_scc0 L_urp_29
    s_mov_b32 s34, 50331648
    buffer_load_dword v176, v175, s[4:7], s34 offen sc1
L_urp_29:
    s_cmp_ge_u32 s32, 15
    s_cbranch_scc1 L_noiss_30
    s_add_u32 m0, s40, 0
    s_mov_b32 s34, 1024
    buffer_load_dwordx4 v12, s[12:15], s34 offen lds
    s_add_u32 m0, s40, 16384
    s_mov_b32 s34, 1966080
    buffer_load_dwordx4 v13, s[16:19], s34 offen lds
    s_add_u32 m0, s40, 4096
    s_mov_b32 s34, 41984
    buffer_load_dwordx4 v12, s[12:15], s34 offen lds
    s_add_u32 m0, s40, 20480
    s_mov_b32 s34, 2027520
    buffer_load_dwordx4 v13, s[16:19], s34 offen lds
    s_add_u32 m0, s40, 8192
    s_mov_b32 s34, 82944
    buffer_load_dwordx4 v12, s[12:15], s34 offen lds
    s_add_u32 m0, s40, 24576
    s_mov_b32 s34, 2088960
    buffer_load_dwordx4 v13, s[16:19], s34 offen lds
    s_add_u32 m0, s40, 12288
    s_mov_b32 s34, 123904
    buffer_load_dwordx4 v12, s[12:15], s34 offen lds
    s_add_u32 m0, s40, 28672
    s_mov_b32 s34, 2150400
    buffer_load_dwordx4 v13, s[16:19], s34 offen lds
L_noiss_30:
    s_waitcnt vmcnt(16)
    s_barrier
    s_cmp_eq_u32 s8, 7
    s_cbranch_scc0 L_urq_31
    s_cmp_lg_u32 s58, 0
    s_cbranch_scc1 L_urq_31
    s_waitcnt vmcnt(8)
    s_cmp_ge_u32 s32, 15
    s_cbranch_scc0 L_spw_32
    s_waitcnt vmcnt(0)
L_spw_32:
    s_movk_i32 s34, 32
    v_cmp_le_u32 vcc, s34, v176
    s_nop 1
    s_cmp_eq_u64 vcc, exec
    s_cbranch_scc0 L_urq_31
    s_mov_b32 s58, 1
    v_mov_b32 v2, 163776
    v_mov_b32 v3, 1
    ds_write_b32 v2, v3 offset:0
    s_waitcnt lgkmcnt(0)
L_urq_31:
    s_cmp_eq_u32 s8, 7
    s_cbranch_scc0 L_urp_33
    s_mov_b32 s34, 50331648
    buffer_load_dword v176, v175, s[4:7], s34 offen sc1
L_urp_33:
    s_cmp_ge_u32 s32, 15
    s_cbranch_scc1 L_noiss_34
    s_add_u32 m0, s40, 32768
    s_mov_b32 s34, 1152
    buffer_load_dwordx4 v12, s[12:15], s34 offen lds
    s_add_u32 m0, s40, 49152
    s_mov_b32 s34, 2211840
    buffer_load_dwordx4 v13, s[16:19], s34 offen lds
    s_add_u32 m0, s40, 36864
    s_mov_b32 s34, 42112
    buffer_load_dwordx4 v12, s[12:15], s34 offen lds
    s_add_u32 m0, s40, 53248
    s_mov_b32 s34, 2273280
    buffer_load_dwordx4 v13, s[16:19], s34 offen lds
    s_add_u32 m0, s40, 40960
    s_mov_b32 s34, 83072
    buffer_load_dwordx4 v12, s[12:15], s34 offen lds
    s_add_u32 m0, s40, 57344
    s_mov_b32 s34, 2334720
    buffer_load_dwordx4 v13, s[16:19], s34 offen lds
    s_add_u32 m0, s40, 45056
    s_mov_b32 s34, 124032
    buffer_load_dwordx4 v12, s[12:15], s34 offen lds
    s_add_u32 m0, s40, 61440
    s_mov_b32 s34, 2396160
    buffer_load_dwordx4 v13, s[16:19], s34 offen lds
L_noiss_34:
    s_waitcnt vmcnt(16)
    s_barrier
    s_cmp_eq_u32 s8, 7
    s_cbranch_scc0 L_urq_35
    s_cmp_lg_u32 s58, 0
    s_cbranch_scc1 L_urq_35
    s_waitcnt vmcnt(8)
    s_cmp_ge_u32 s32, 15
    s_cbranch_scc0 L_spw_36
    s_waitcnt vmcnt(0)
L_spw_36:
    s_movk_i32 s34, 32
    v_cmp_le_u32 vcc, s34, v176
    s_nop 1
    s_cmp_eq_u64 vcc, exec
    s_cbranch_scc0 L_urq_35
    s_mov_b32 s58, 1
    v_mov_b32 v2, 163776
    v_mov_b32 v3, 1
    ds_write_b32 v2, v3 offset:0
    s_waitcnt lgkmcnt(0)
L_urq_35:
    s_bitcmp1_b32 s59, 0
    s_cbranch_scc0 L_noch_37
    v_mov_b32 v2, 163776
    ds_read_b32 v3, v2 offset:0
    s_waitcnt lgkmcnt(0)
    v_readfirstlane_b32 s34, v3
    s_cmp_eq_u32 s34, 0
    s_cbranch_scc1 L_noch_37
    s_mov_b32 s58, 1
    s_lshl_b32 s60, s56, 12
    s_add_u32 s60, s60, 12582912
    s_add_u32 m0, s63, 0
    s_sub_u32 s61, s60, 2
    buffer_load_dwordx4 v19, s[4:7], s61 offen lds
    s_add_u32 m0, s63, 1024
    s_add_u32 s61, s60, 1022
    buffer_load_dwordx4 v19, s[4:7], s61 offen lds
    s_add_u32 m0, s63, 2048
    s_add_u32 s61, s60, 2046
    buffer_load_dwordx4 v19, s[4:7], s61 offen lds
    s_add_u32 m0, s63, 3072
    s_add_u32 s61, s60, 3070
    buffer_load_dwordx4 v19, s[4:7], s61 offen lds
    s_mov_b64 exec, 1
    s_add_u32 m0, s63, 4096
    s_add_u32 s61, s60, 4094
    buffer_load_dwordx4 v19, s[4:7], s61 offen lds
    s_mov_b64 exec, -1
    s_add_u32 m0, s63, 4640
    s_sub_u32 s61, s60, 4
    buffer_load_dwordx4 v19, s[4:7], s61 offen lds
    s_add_u32 m0, s63, 5664
    s_add_u32 s61, s60, 1020
    buffer_load_dwordx4 v19, s[4:7], s61 offen lds
    s_add_u32 m0, s63, 6688
    s_add_u32 s61, s60, 2044
    buffer_load_dwordx4 v19, s[4:7], s61 offen lds
    s_add_u32 m0, s63, 7712
    s_add_u32 s61, s60, 3068
    buffer_load_dwordx4 v19, s[4:7], s61 offen lds
    s_mov_b64 exec, 1
    s_add_u32 m0, s63, 8736
    s_add_u32 s61, s60, 4092
    buffer_load_dwordx4 v19, s[4:7], s61 offen lds
    s_mov_b64 exec, -1
L_noch_37:
    s_bitcmp1_b32 s59, 0
    s_cbranch_scc0 L_w9_38
    s_cmp_eq_u32 s58, 0
    s_cbranch_scc1 L_w9_38
    s_waitcnt vmcnt(10)
    s_branch L_w9d_39
L_w9_38:
    s_waitcnt vmcnt(0)
L_w9d_39:
    s_barrier
    s_cmp_eq_u32 s8, 7
    s_cbranch_scc0 L_nopoll_40
    s_bitcmp1_b32 s59, 1
    s_cbranch_scc0 L_nopoll_40
    s_cmp_lg_u32 s58, 0
    s_cbranch_scc1 L_nopoll_40
    s_mov_b32 s92, 0
    s_mov_b32 s93, 50331648
L_wcnt_41:
    buffer_load_dword v3, v175, s[4:7], s93 offen sc1
    s_add_u32 s92, s92, 1
    s_waitcnt vmcnt(0)
    v_cmp_le_u32 vcc, 32, v3
    s_nop 1
    s_cmp_eq_u64 vcc, exec
    s_cbranch_scc1 L_wcntd_42
    s_sleep 3
    s_cmp_lt_u32 s92, 131072
    s_cbranch_scc1 L_wcnt_41
L_wcntd_42:
    v_mov_b32 v2, 163776
    v_mov_b32 v3, 1
    ds_write_b32 v2, v3 offset:0
    s_waitcnt lgkmcnt(0)
L_nopoll_40:
    s_bitcmp1_b32 s59, 0
    s_cbranch_scc0 L_conv_end
    s_mul_i32 s24, s56, 52429
    s_lshr_b32 s24, s24, 22
    v_lshlrev_b32 v12, 4, v1
    s_cmp_lg_u32 s58, 0
    s_cbranch_scc1 L_upre_43
    v_mov_b32 v2, 163776
    s_mov_b32 s92, 0
L_lw_44:
    ds_read_b32 v3, v2 offset:0
    s_add_u32 s92, s92, 1
    s_waitcnt lgkmcnt(0)
    v_readfirstlane_b32 s93, v3
    s_cmp_lg_u32 s93, 0
    s_cbranch_scc1 L_lwd_45
    s_sleep 1
    s_cmp_lt_u32 s92, 2097152
    s_cbranch_scc1 L_lw_44
L_lwd_45:
    s_lshl_b32 s60, s56, 12
    s_add_u32 s60, s60, 12582912
    s_add_u32 m0, s63, 0
    s_sub_u32 s61, s60, 2
    buffer_load_dwordx4 v12, s[4:7], s61 offen lds
    s_add_u32 m0, s63, 1024
    s_add_u32 s61, s60, 1022
    buffer_load_dwordx4 v12, s[4:7], s61 offen lds
    s_add_u32 m0, s63, 2048
    s_add_u32 s61, s60, 2046
    buffer_load_dwordx4 v12, s[4:7], s61 offen lds
    s_add_u32 m0, s63, 3072
    s_add_u32 s61, s60, 3070
    buffer_load_dwordx4 v12, s[4:7], s61 offen lds
    s_mov_b64 exec, 1
    s_add_u32 m0, s63, 4096
    s_add_u32 s61, s60, 4094
    buffer_load_dwordx4 v12, s[4:7], s61 offen lds
    s_mov_b64 exec, -1
    s_add_u32 m0, s63, 4640
    s_sub_u32 s61, s60, 4
    buffer_load_dwordx4 v12, s[4:7], s61 offen lds
    s_add_u32 m0, s63, 5664
    s_add_u32 s61, s60, 1020
    buffer_load_dwordx4 v12, s[4:7], s61 offen lds
    s_add_u32 m0, s63, 6688
    s_add_u32 s61, s60, 2044
    buffer_load_dwordx4 v12, s[4:7], s61 offen lds
    s_add_u32 m0, s63, 7712
    s_add_u32 s61, s60, 3068
    buffer_load_dwordx4 v12, s[4:7], s61 offen lds
    s_mov_b64 exec, 1
    s_add_u32 m0, s63, 8736
    s_add_u32 s61, s60, 4092
    buffer_load_dwordx4 v12, s[4:7], s61 offen lds
    s_mov_b64 exec, -1
L_upre_43:
    v_mov_b32 v184, 0
    v_mov_b32 v185, 0
    v_mov_b32 v186, 0
    v_mov_b32 v187, 0
    v_lshlrev_b32 v189, 4, v1
    v_add_u32 v189, s57, v189
    v_mov_b32 v190, s57
    s_waitcnt lgkmcnt(0)
    s_and_b32 s60, s56, 1
    s_lshl_b32 s60, s60, 4
    s_lshr_b32 s35, s11, s60
    s_lshl_b32 s35, s35, 16
    s_lshl_b32 s60, s10, 16
    v_mov_b32 v188, s60
    v_add_f32 v188, s35, v188
    s_and_b32 s60, s10, 0xffff0000
    s_mov_b64 exec, 0xf
    ds_write_b128 v189, v[184:187] offset:0
    ds_write_b128 v189, v[184:187] offset:4480
    s_mov_b64 exec, -1
    v_cvt_pk_bf16_f32 v188, v188, v188
    v_and_b32 v188, 0xffff, v188
    v_or_b32 v188, s60, v188
    s_mov_b64 exec, 1
    ds_write_b32 v190, v188 offset:64
    ds_write_b32 v190, v188 offset:4540
    s_mov_b64 exec, -1
    v_lshlrev_b32 v182, 4, v1
    v_add_u32 v182, s63, v182
    v_mov_b32 v183, s63
    v_lshlrev_b32 v191, 1, v1
    v_add_u32 v191, s63, v191
    v_and_b32 v4, 1, v1
    v_mul_u32_u24 v13, 4480, v4
    v_bfe_u32 v5, v1, 1, 3
    v_lshl_add_u32 v13, v5, 3, v13
    v_lshrrev_b32 v6, 4, v1
    v_lshl_add_u32 v13, v6, 4, v13
    s_add_u32 s17, s57, 0
    v_add_u32 v13, s17, v13
    v_mul_u32_u24 v14, 4640, v4
    v_lshl_add_u32 v14, v6, 4, v14
    v_lshlrev_b32 v5, 6, v5
    v_sub_u32 v14, v14, v5
    s_add_u32 s17, s63, 448
    v_add_u32 v14, s17, v14
    v_mov_b32 v16, 0
    v_mov_b32 v17, 0
    v_mov_b32 v18, 0
    v_mov_b32 v19, 0
    v_mov_b32 v20, 0
    v_mov_b32 v21, 0
    v_mov_b32 v22, 0
    v_mov_b32 v23, 0
    v_mov_b32 v24, 0
    v_mov_b32 v25, 0
    v_mov_b32 v26, 0
    v_mov_b32 v27, 0
    v_mov_b32 v28, 0
    v_mov_b32 v29, 0
    v_mov_b32 v30, 0
    v_mov_b32 v31, 0
    v_mov_b32 v32, 0
    v_mov_b32 v33, 0
    v_mov_b32 v34, 0
    v_mov_b32 v35, 0
    v_mov_b32 v36, 0
    v_mov_b32 v37, 0
    v_mov_b32 v38, 0
    v_mov_b32 v39, 0
    v_mov_b32 v40, 0
    v_mov_b32 v41, 0
    v_mov_b32 v42, 0
    v_mov_b32 v43, 0
    v_mov_b32 v44, 0
    v_mov_b32 v45, 0
    v_mov_b32 v46, 0
    v_mov_b32 v47, 0
    v_and_b32 v8, 1, v1
    v_cmp_eq_u32 vcc, 1, v8
    v_mov_b32 v9, 0x03020100
    v_mov_b32 v10, 0x07060504
    v_cndmask_b32 v178, v10, v9, vcc
    v_mov_b32 v9, 0x01000504
    v_mov_b32 v10, 0x05040100
    v_cndmask_b32 v176, v9, v10, vcc
    v_mov_b32 v9, 0x03020706
    v_mov_b32 v10, 0x07060302
    v_cndmask_b32 v177, v9, v10, vcc
    v_bfe_u32 v9, v1, 1, 3
    v_lshlrev_b32 v179, 6, v9
    v_lshrrev_b32 v9, 4, v1
    v_lshl_add_u32 v179, v9, 4, v179
    v_lshl_add_u32 v179, v8, 3, v179
    s_lshl_b32 s17, s56, 12
    s_add_u32 s17, s17, 18874368
    s_mov_b32 s62, s17
    s_waitcnt vmcnt(0)
    s_mov_b64 exec, 0x7fffffff
    ds_write_b128 v182, v[184:187] offset:4112
    ds_write_b128 v182, v[184:187] offset:8752
    s_mov_b64 exec, 0x7f
    ds_write_b16 v191, v184 offset:4098
    s_mov_b64 exec, 0x3f
    ds_write_b16 v191, v184 offset:8740
    s_mov_b64 exec, 1
    ds_write_b16 v183, v184 offset:0
    ds_write_b32 v183, v184 offset:4640
    s_mov_b64 exec, -1
    ds_read_b64 v[80:81], v13 offset:0
    ds_read_b64 v[82:83], v13 offset:8
    ds_read_b128 v[144:147], v14 offset:3584
    ds_read_b128 v[148:151], v14 offset:3072
    ds_read_b128 v[152:155], v14 offset:2560
    ds_read_b128 v[156:159], v14 offset:2048
    ds_read_b128 v[160:163], v14 offset:1536
    ds_read_b128 v[164:167], v14 offset:1024
    ds_read_b128 v[168:171], v14 offset:512
    ds_read_b128 v[172:175], v14 offset:0
    v_add_u32 v13, 64, v13
    v_add_u32 v14, 64, v14
    s_waitcnt lgkmcnt(0)
    ds_read_b64 v[48:49], v13 offset:0
    ds_read_b64 v[50:51], v13 offset:8
    ds_read_b128 v[112:115], v14 offset:3584
    ds_read_b64 v[52:53], v13 offset:512
    ds_read_b64 v[54:55], v13 offset:520
    ds_read_b128 v[116:119], v14 offset:3072
    ds_read_b64 v[56:57], v13 offset:1024
    ds_read_b64 v[58:59], v13 offset:1032
    ds_read_b128 v[120:123], v14 offset:2560
    ds_read_b64 v[60:61], v13 offset:1536
    ds_read_b64 v[62:63], v13 offset:1544
    ds_read_b128 v[124:127], v14 offset:2048
    s_waitcnt lgkmcnt(0)
    ds_read_b64 v[64:65], v13 offset:2048
    ds_read_b64 v[66:67], v13 offset:2056
    ds_read_b128 v[128:131], v14 offset:1536
    ds_read_b64 v[68:69], v13 offset:2560
    ds_read_b64 v[70:71], v13 offset:2568
    ds_read_b128 v[132:135], v14 offset:1024
    ds_read_b64 v[72:73], v13 offset:3072
    ds_read_b64 v[74:75], v13 offset:3080
    ds_read_b128 v[136:139], v14 offset:512
    ds_read_b64 v[76:77], v13 offset:3584
    ds_read_b64 v[78:79], v13 offset:3592
    ds_read_b128 v[140:143], v14 offset:0
    v_add_u32 v13, 64, v13
    v_add_u32 v14, 64, v14
    v_mfma_f32_16x16x32_bf16 v[16:19], v[80:83], v[144:147], v[16:19]
    v_mfma_f32_16x16x32_bf16 v[20:23], v[80:83], v[148:151], v[20:23]
    v_mfma_f32_16x16x32_bf16 v[24:27], v[80:83], v[152:155], v[24:27]
    v_mfma_f32_16x16x32_bf16 v[28:31], v[80:83], v[156:159], v[28:31]
    v_mfma_f32_16x16x32_bf16 v[32:35], v[80:83], v[160:163], v[32:35]
    v_mfma_f32_16x16x32_bf16 v[36:39], v[80:83], v[164:167], v[36:39]
    v_mfma_f32_16x16x32_bf16 v[40:43], v[80:83], v[168:171], v[40:43]
    v_mfma_f32_16x16x32_bf16 v[44:47], v[80:83], v[172:175], v[44:47]
    s_waitcnt lgkmcnt(0)
    s_mov_b32 s20, 0
L_conv_loop:
    v_mfma_f32_16x16x32_bf16 v[16:19], v[48:51], v[112:115], v[16:19]
    v_mfma_f32_16x16x32_bf16 v[20:23], v[48:51], v[116:119], v[20:23]
    v_mfma_f32_16x16x32_bf16 v[24:27], v[48:51], v[120:123], v[24:27]
    ds_read_b64 v[80:81], v13 offset:0
    v_mfma_f32_16x16x32_bf16 v[28:31], v[48:51], v[124:127], v[28:31]
    ds_read_b64 v[82:83], v13 offset:8
    v_mfma_f32_16x16x32_bf16 v[32:35], v[48:51], v[128:131], v[32:35]
    ds_read_b128 v[144:147], v14 offset:3584
    v_mfma_f32_16x16x32_bf16 v[36:39], v[48:51], v[132:135], v[36:39]
    ds_read_b64 v[84:85], v13 offset:512
    v_mfma_f32_16x16x32_bf16 v[40:43], v[48:51], v[136:139], v[40:43]
    ds_read_b64 v[86:87], v13 offset:520
    v_mfma_f32_16x16x32_bf16 v[44:47], v[48:51], v[140:143], v[44:47]
    ds_read_b128 v[148:151], v14 offset:3072
    v_mfma_f32_16x16x32_bf16 v[20:23], v[52:55], v[112:115], v[20:23]
    ds_read_b64 v[88:89], v13 offset:1024
    v_mfma_f32_16x16x32_bf16 v[24:27], v[52:55], v[116:119], v[24:27]
    ds_read_b64 v[90:91], v13 offset:1032
    v_mfma_f32_16x16x32_bf16 v[28:31], v[52:55], v[120:123], v[28:31]
    ds_read_b128 v[152:155], v14 offset:2560
    v_mfma_f32_16x16x32_bf16 v[32:35], v[52:55], v[124:127], v[32:35]
    ds_read_b64 v[92:93], v13 offset:1536
    v_mfma_f32_16x16x32_bf16 v[36:39], v[52:55], v[128:131], v[36:39]
    ds_read_b64 v[94:95], v13 offset:1544
    v_mfma_f32_16x16x32_bf16 v[40:43], v[52:55], v[132:135], v[40:43]
    ds_read_b128 v[156:159], v14 offset:2048
    v_mfma_f32_16x16x32_bf16 v[44:47], v[52:55], v[136:139], v[44:47]
    ds_read_b64 v[96:97], v13 offset:2048
    v_mfma_f32_16x16x32_bf16 v[24:27], v[56:59], v[112:115], v[24:27]
    ds_read_b64 v[98:99], v13 offset:2056
    v_mfma_f32_16x16x32_bf16 v[28:31], v[56:59], v[116:119], v[28:31]
    ds_read_b128 v[160:163], v14 offset:1536
    v_mfma_f32_16x16x32_bf16 v[32:35], v[56:59], v[120:123], v[32:35]
    ds_read_b64 v[100:101], v13 offset:2560
    v_mfma_f32_16x16x32_bf16 v[36:39], v[56:59], v[124:127], v[36:39]
    ds_read_b64 v[102:103], v13 offset:2568
    v_mfma_f32_16x16x32_bf16 v[40:43], v[56:59], v[128:131], v[40:43]
    ds_read_b128 v[164:167], v14 offset:1024
    v_mfma_f32_16x16x32_bf16 v[44:47], v[56:59], v[132:135], v[44:47]
    ds_read_b64 v[104:105], v13 offset:3072
    v_mfma_f32_16x16x32_bf16 v[28:31], v[60:63], v[112:115], v[28:31]
    ds_read_b64 v[106:107], v13 offset:3080
    v_mfma_f32_16x16x32_bf16 v[32:35], v[60:63], v[116:119], v[32:35]
    ds_read_b128 v[168:171], v14 offset:512
    v_mfma_f32_16x16x32_bf16 v[36:39], v[60:63], v[120:123], v[36:39]
    ds_read_b64 v[108:109], v13 offset:3584
    v_mfma_f32_16x16x32_bf16 v[40:43], v[60:63], v[124:127], v[40:43]
    ds_read_b64 v[110:111], v13 offset:3592
    v_mfma_f32_16x16x32_bf16 v[44:47], v[60:63], v[128:131], v[44:47]
    ds_read_b128 v[172:175], v14 offset:0
    v_mfma_f32_16x16x32_bf16 v[32:35], v[64:67], v[112:115], v[32:35]
    v_mfma_f32_16x16x32_bf16 v[36:39], v[64:67], v[116:119], v[36:39]
    v_mfma_f32_16x16x32_bf16 v[40:43], v[64:67], v[120:123], v[40:43]
    v_mfma_f32_16x16x32_bf16 v[44:47], v[64:67], v[124:127], v[44:47]
    v_mfma_f32_16x16x32_bf16 v[36:39], v[68:71], v[112:115], v[36:39]
    v_mfma_f32_16x16x32_bf16 v[40:43], v[68:71], v[116:119], v[40:43]
    v_mfma_f32_16x16x32_bf16 v[44:47], v[68:71], v[120:123], v[44:47]
    v_mfma_f32_16x16x32_bf16 v[40:43], v[72:75], v[112:115], v[40:43]
    v_mfma_f32_16x16x32_bf16 v[44:47], v[72:75], v[116:119], v[44:47]
    v_mfma_f32_16x16x32_bf16 v[44:47], v[76:79], v[112:115], v[44:47]
    v_add_u32 v13, 64, v13
    v_add_u32 v14, 64, v14
    s_waitcnt lgkmcnt(0)
    v_mfma_f32_16x16x32_bf16 v[16:19], v[80:83], v[144:147], v[16:19]
    v_mfma_f32_16x16x32_bf16 v[20:23], v[80:83], v[148:151], v[20:23]
    v_mfma_f32_16x16x32_bf16 v[24:27], v[80:83], v[152:155], v[24:27]
    ds_read_b64 v[48:49], v13 offset:0
    v_mfma_f32_16x16x32_bf16 v[28:31], v[80:83], v[156:159], v[28:31]
    ds_read_b64 v[50:51], v13 offset:8
    v_mfma_f32_16x16x32_bf16 v[32:35], v[80:83], v[160:163], v[32:35]
    ds_read_b128 v[112:115], v14 offset:3584
    v_mfma_f32_16x16x32_bf16 v[36:39], v[80:83], v[164:167], v[36:39]
    ds_read_b64 v[52:53], v13 offset:512
    v_mfma_f32_16x16x32_bf16 v[40:43], v[80:83], v[168:171], v[40:43]
    ds_read_b64 v[54:55], v13 offset:520
    v_mfma_f32_16x16x32_bf16 v[44:47], v[80:83], v[172:175], v[44:47]
    ds_read_b128 v[116:119], v14 offset:3072
    v_mfma_f32_16x16x32_bf16 v[20:23], v[84:87], v[144:147], v[20:23]
    ds_read_b64 v[56:57], v13 offset:1024
    v_mfma_f32_16x16x32_bf16 v[24:27], v[84:87], v[148:151], v[24:27]
    ds_read_b64 v[58:59], v13 offset:1032
    v_mfma_f32_16x16x32_bf16 v[28:31], v[84:87], v[152:155], v[28:31]
    ds_read_b128 v[120:123], v14 offset:2560
    v_mfma_f32_16x16x32_bf16 v[32:35], v[84:87], v[156:159], v[32:35]
    ds_read_b64 v[60:61], v13 offset:1536
    v_mfma_f32_16x16x32_bf16 v[36:39], v[84:87], v[160:163], v[36:39]
    ds_read_b64 v[62:63], v13 offset:1544
    v_mfma_f32_16x16x32_bf16 v[40:43], v[84:87], v[164:167], v[40:43]
    ds_read_b128 v[124:127], v14 offset:2048
    v_mfma_f32_16x16x32_bf16 v[44:47], v[84:87], v[168:171], v[44:47]
    ds_read_b64 v[64:65], v13 offset:2048
    v_mfma_f32_16x16x32_bf16 v[24:27], v[88:91], v[144:147], v[24:27]
    ds_read_b64 v[66:67], v13 offset:2056
    v_mfma_f32_16x16x32_bf16 v[28:31], v[88:91], v[148:151], v[28:31]
    ds_read_b128 v[128:131], v14 offset:1536
    v_mfma_f32_16x16x32_bf16 v[32:35], v[88:91], v[152:155], v[32:35]
    ds_read_b64 v[68:69], v13 offset:2560
    v_mfma_f32_16x16x32_bf16 v[36:39], v[88:91], v[156:159], v[36:39]
    ds_read_b64 v[70:71], v13 offset:2568
    v_mfma_f32_16x16x32_bf16 v[40:43], v[88:91], v[160:163], v[40:43]
    ds_read_b128 v[132:135], v14 offset:1024
    v_mfma_f32_16x16x32_bf16 v[44:47], v[88:91], v[164:167], v[44:47]
    ds_read_b64 v[72:73], v13 offset:3072
    v_mfma_f32_16x16x32_bf16 v[28:31], v[92:95], v[144:147], v[28:31]
    ds_read_b64 v[74:75], v13 offset:3080
    v_mfma_f32_16x16x32_bf16 v[32:35], v[92:95], v[148:151], v[32:35]
    ds_read_b128 v[136:139], v14 offset:512
    v_mfma_f32_16x16x32_bf16 v[36:39], v[92:95], v[152:155], v[36:39]
    ds_read_b64 v[76:77], v13 offset:3584
    v_mfma_f32_16x16x32_bf16 v[40:43], v[92:95], v[156:159], v[40:43]
    ds_read_b64 v[78:79], v13 offset:3592
    v_mfma_f32_16x16x32_bf16 v[44:47], v[92:95], v[160:163], v[44:47]
    ds_read_b128 v[140:143], v14 offset:0
    v_mfma_f32_16x16x32_bf16 v[32:35], v[96:99], v[144:147], v[32:35]
    v_mfma_f32_16x16x32_bf16 v[36:39], v[96:99], v[148:151], v[36:39]
    v_mfma_f32_16x16x32_bf16 v[40:43], v[96:99], v[152:155], v[40:43]
    v_mfma_f32_16x16x32_bf16 v[44:47], v[96:99], v[156:159], v[44:47]
    v_mfma_f32_16x16x32_bf16 v[36:39], v[100:103], v[144:147], v[36:39]
    v_mfma_f32_16x16x32_bf16 v[40:43], v[100:103], v[148:151], v[40:43]
    v_mfma_f32_16x16x32_bf16 v[44:47], v[100:103], v[152:155], v[44:47]
    v_mfma_f32_16x16x32_bf16 v[40:43], v[104:107], v[144:147], v[40:43]
    v_mfma_f32_16x16x32_bf16 v[44:47], v[104:107], v[148:151], v[44:47]
    v_mfma_f32_16x16x32_bf16 v[44:47], v[108:111], v[144:147], v[44:47]
    v_add_u32 v13, 64, v13
    v_add_u32 v14, 64, v14
    s_waitcnt lgkmcnt(0)
    s_add_u32 s20, s20, 1
    s_cmp_lt_u32 s20, 4
    s_cbranch_scc1 L_conv_loop
    s_nop 3
    v_cvt_pk_bf16_f32 v48, v16, v17
    v_cvt_pk_bf16_f32 v49, v18, v19
    s_nop 1
    v_mov_b32_dpp v50, v48 quad_perm:[1,0,3,2] row_mask:0xf bank_mask:0xf
    v_mov_b32_dpp v51, v49 quad_perm:[1,0,3,2] row_mask:0xf bank_mask:0xf
    v_perm_b32 v52, v48, v49, v178
    v_perm_b32 v53, v50, v51, v178
    v_perm_b32 v224, v52, v53, v176
    v_perm_b32 v225, v52, v53, v177
    v_cvt_pk_bf16_f32 v56, v20, v21
    v_cvt_pk_bf16_f32 v57, v22, v23
    s_nop 1
    v_mov_b32_dpp v58, v56 quad_perm:[1,0,3,2] row_mask:0xf bank_mask:0xf
    v_mov_b32_dpp v59, v57 quad_perm:[1,0,3,2] row_mask:0xf bank_mask:0xf
    v_perm_b32 v60, v56, v57, v178
    v_perm_b32 v61, v58, v59, v178
    v_perm_b32 v226, v60, v61, v176
    v_perm_b32 v227, v60, v61, v177
    v_cvt_pk_bf16_f32 v64, v24, v25
    v_cvt_pk_bf16_f32 v65, v26, v27
    s_nop 1
    v_mov_b32_dpp v66, v64 quad_perm:[1,0,3,2] row_mask:0xf bank_mask:0xf
    v_mov_b32_dpp v67, v65 quad_perm:[1,0,3,2] row_mask:0xf bank_mask:0xf
    v_perm_b32 v68, v64, v65, v178
    v_perm_b32 v69, v66, v67, v178
    v_perm_b32 v228, v68, v69, v176
    v_perm_b32 v229, v68, v69, v177
    v_cvt_pk_bf16_f32 v72, v28, v29
    v_cvt_pk_bf16_f32 v73, v30, v31
    s_nop 1
    v_mov_b32_dpp v74, v72 quad_perm:[1,0,3,2] row_mask:0xf bank_mask:0xf
    v_mov_b32_dpp v75, v73 quad_perm:[1,0,3,2] row_mask:0xf bank_mask:0xf
    v_perm_b32 v76, v72, v73, v178
    v_perm_b32 v77, v74, v75, v178
    v_perm_b32 v230, v76, v77, v176
    v_perm_b32 v231, v76, v77, v177
    v_cvt_pk_bf16_f32 v48, v32, v33
    v_cvt_pk_bf16_f32 v49, v34, v35
    s_nop 1
    v_mov_b32_dpp v50, v48 quad_perm:[1,0,3,2] row_mask:0xf bank_mask:0xf
    v_mov_b32_dpp v51, v49 quad_perm:[1,0,3,2] row_mask:0xf bank_mask:0xf
    v_perm_b32 v52, v48, v49, v178
    v_perm_b32 v53, v50, v51, v178
    v_perm_b32 v232, v52, v53, v176
    v_perm_b32 v233, v52, v53, v177
    v_cvt_pk_bf16_f32 v56, v36, v37
    v_cvt_pk_bf16_f32 v57, v38, v39
    s_nop 1
    v_mov_b32_dpp v58, v56 quad_perm:[1,0,3,2] row_mask:0xf bank_mask:0xf
    v_mov_b32_dpp v59, v57 quad_perm:[1,0,3,2] row_mask:0xf bank_mask:0xf
    v_perm_b32 v60, v56, v57, v178
    v_perm_b32 v61, v58, v59, v178
    v_perm_b32 v234, v60, v61, v176
    v_perm_b32 v235, v60, v61, v177
    v_cvt_pk_bf16_f32 v64, v40, v41
    v_cvt_pk_bf16_f32 v65, v42, v43
    s_nop 1
    v_mov_b32_dpp v66, v64 quad_perm:[1,0,3,2] row_mask:0xf bank_mask:0xf
    v_mov_b32_dpp v67, v65 quad_perm:[1,0,3,2] row_mask:0xf bank_mask:0xf
    v_perm_b32 v68, v64, v65, v178
    v_perm_b32 v69, v66, v67, v178
    v_perm_b32 v236, v68, v69, v176
    v_perm_b32 v237, v68, v69, v177
    v_cvt_pk_bf16_f32 v72, v44, v45
    v_cvt_pk_bf16_f32 v73, v46, v47
    s_nop 1
    v_mov_b32_dpp v74, v72 quad_perm:[1,0,3,2] row_mask:0xf bank_mask:0xf
    v_mov_b32_dpp v75, v73 quad_perm:[1,0,3,2] row_mask:0xf bank_mask:0xf
    v_perm_b32 v76, v72, v73, v178
    v_perm_b32 v77, v74, v75, v178
    v_perm_b32 v238, v76, v77, v176
    v_perm_b32 v239, v76, v77, v177
    v_mov_b32 v240, v179
L_conv_end:
L_p1_end:
    s_and_b32 s12, s2, 7
    s_lshl_b32 s12, s12, 2
    s_bfe_u32 s14, s2, 0x20003
    s_add_u32 s12, s12, s14
    s_lshr_b32 s33, s2, 5
    s_lshl_b32 s18, s33, 3
    s_and_b32 s17, s8, 3
    s_lshr_b32 s16, s8, 2
    s_lshl_b32 s14, s17, 1
    s_add_u32 s18, s18, s14
    v_lshlrev_b32 v17, 4, v1
    v_and_b32 v18, 31, v1
    v_lshlrev_b32 v15, 3, v18
    v_lshrrev_b32 v19, 5, v1
    v_lshlrev_b32 v20, 15, v19
    v_add_u32 v20, v20, v15
    s_mul_i32 s31, s12, 81920
    s_lshl_b32 s14, s18, 8
    s_add_u32 s14, s14, s31
    s_add_u32 s15, s14, 16384
    s_add_u32 s27, s8, 0
    s_cmp_ge_u32 s27, 10
    s_cselect_b32 s24, 1, 0
    s_mul_i32 s32, s24, 10
    s_sub_u32 s27, s27, s32
    s_mul_i32 s32, s24, 12672
    s_lshl_b32 s24, s24, 13
    s_add_u32 s24, s24, s31
    s_add_u32 s24, s24, 2621440
    s_cmp_ge_u32 s27, 5
    s_cselect_b32 s30, 2539520, 0
    s_add_u32 s24, s24, s30
    s_lshl_b32 s30, s27, 14
    s_add_u32 s24, s24, s30
    s_mul_i32 s27, s27, 1056
    s_add_u32 s27, s27, s32
    s_add_u32 s28, s8, 8
    s_cmp_ge_u32 s28, 10
    s_cselect_b32 s25, 1, 0
    s_mul_i32 s32, s25, 10
    s_sub_u32 s28, s28, s32
    s_mul_i32 s32, s25, 12672
    s_lshl_b32 s25, s25, 13
    s_add_u32 s25, s25, s31
    s_add_u32 s25, s25, 2621440
    s_cmp_ge_u32 s28, 5
    s_cselect_b32 s30, 2539520, 0
    s_add_u32 s25, s25, s30
    s_lshl_b32 s30, s28, 14
    s_add_u32 s25, s25, s30
    s_mul_i32 s28, s28, 1056
    s_add_u32 s28, s28, s32
    s_add_u32 s29, s8, 16
    s_cmp_ge_u32 s29, 10
    s_cselect_b32 s26, 1, 0
    s_mul_i32 s32, s26, 10
    s_sub_u32 s29, s29, s32
    s_mul_i32 s32, s26, 12672
    s_lshl_b32 s26, s26, 13
    s_add_u32 s26, s26, s31
    s_add_u32 s26, s26, 2621440
    s_cmp_ge_u32 s29, 5
    s_cselect_b32 s30, 2539520, 0
    s_add_u32 s26, s26, s30
    s_lshl_b32 s30, s29, 14
    s_add_u32 s26, s26, s30
    s_mul_i32 s29, s29, 1056
    s_add_u32 s29, s29, s32
    s_cmp_lg_u32 s8, 0
    s_cbranch_scc1 L_nopoll_46
    v_min_u32 v21, 5, v1
    v_and_b32 v22, 1, v21
    v_lshlrev_b32 v22, 2, v22
    s_mul_i32 s32, s12, 5
    v_add_u32 v22, s32, v22
    v_lshrrev_b32 v22, 5, v22
    v_lshrrev_b32 v21, 1, v21
    v_mul_u32_u24 v21, 5, v21
    v_add_u32 v21, v21, v22
    v_lshlrev_b32 v21, 8, v21
    s_mov_b32 s92, 0
    s_mov_b32 s93, 50331648
L_wcnt_47:
    buffer_load_dword v3, v21, s[4:7], s93 offen sc1
    s_add_u32 s92, s92, 1
    s_waitcnt vmcnt(0)
    v_cmp_le_u32 vcc, 16, v3
    s_nop 1
    s_cmp_eq_u64 vcc, exec
    s_cbranch_scc1 L_wcntd_48
    s_sleep 3
    s_cmp_lt_u32 s92, 131072
    s_cbranch_scc1 L_wcnt_47
L_wcntd_48:
L_nopoll_46:
    s_barrier
    buffer_load_dwordx2 v[24:25], v20, s[4:7], s14 offen offset:0
    buffer_load_dwordx2 v[26:27], v20, s[4:7], s15 offen offset:0
    buffer_load_dwordx2 v[28:29], v20, s[4:7], s14 offen offset:256
    buffer_load_dwordx2 v[30:31], v20, s[4:7], s15 offen offset:256
    s_add_u32 s14, s14, 65536
    buffer_load_dwordx2 v[36:37], v15, s[4:7], s14 offen offset:0
    buffer_load_dwordx2 v[38:39], v15, s[4:7], s14 offen offset:256
    s_add_u32 m0, s27, 0
    s_nop 0
    buffer_load_dwordx4 v17, s[4:7], s24 offen lds
    s_add_u32 s24, s24, 1024
    s_add_u32 m0, s28, 0
    s_nop 0
    buffer_load_dwordx4 v17, s[4:7], s25 offen lds
    s_add_u32 s25, s25, 1024
    s_cmp_ge_u32 s8, 4
    s_cbranch_scc1 L_p2_49
    s_add_u32 m0, s29, 0
    s_nop 0
    buffer_load_dwordx4 v17, s[4:7], s26 offen lds
    s_add_u32 s26, s26, 1024
L_p2_49:
    s_add_u32 m0, s27, 25344
    s_nop 0
    buffer_load_dwordx4 v17, s[4:7], s24 offen lds
    s_add_u32 s24, s24, 1024
    s_add_u32 m0, s28, 25344
    s_nop 0
    buffer_load_dwordx4 v17, s[4:7], s25 offen lds
    s_add_u32 s25, s25, 1024
    s_mul_i32 s32, s8, 12672
    s_add_u32 s32, s32, 10560
    v_add_u32 v18, s32, v17
    v_mov_b32 v44, 0x3f80
    v_mov_b32 v45, 0
    v_mov_b32 v46, 0x3f80
    v_mov_b32 v47, 0
    ds_write_b128 v18, v[44:47]
    v_mov_b32 v48, 0
    v_mov_b32 v49, 0
    v_mov_b32 v50, 0
    v_mov_b32 v51, 0
    ds_write_b128 v18, v[48:51] offset:1056
    s_mul_i32 s14, s16, 12672
    v_mul_u32_u24 v14, 2112, v19
    v_add_u32 v14, v14, v15
    v_add_u32 v14, s14, v14
    v_add_u32 v15, 4224, v15
    v_add_u32 v15, s14, v15
    v_lshlrev_b32 v18, 2, v19
    v_bfe_u32 v21, v1, 2, 2
    v_add_u32 v18, v18, v21
    v_lshlrev_b32 v16, 3, v18
    v_and_b32 v18, 3, v1
    v_min_u32 v21, 2, v18
    v_add_u32 v21, 4, v21
    v_bfe_u32 v22, v1, 4, 1
    v_cmp_eq_u32 vcc, 1, v22
    s_add_u32 s14, s14, 5280
    s_nop 0
    v_cndmask_b32 v18, v18, v21, vcc
    v_mul_u32_u24 v18, 1056, v18
    v_add_u32 v16, v16, v18
    v_add_u32 v16, s14, v16
    v_mov_b32 v4, v14
    v_mov_b32 v5, v15
    v_mov_b32 v6, v16
    s_mov_b32 s13, 50688
    s_mov_b32 s32, 0
    s_mov_b32 s30, 50688
    v_min_u32 v12, 8, v1
    v_add_u32 v12, 40, v12
    v_lshlrev_b32 v12, 8, v12
    v_mov_b32 v13, 32
    v_cmp_gt_u32 vcc, 8, v1
    v_mov_b32 v21, 3840
    v_mov_b32 v22, 64
    v_cndmask_b32 v12, v21, v12, vcc
    v_cndmask_b32 v13, v22, v13, vcc
    s_mov_b32 s57, 0
    s_mov_b32 s35, 50331648
    s_mov_b32 s19, 0
    s_add_u32 s34, s18, s16
    s_mul_i32 s34, s34, 40960
    s_add_u32 s34, s34, 8388608
    v_and_b32 v18, 15, v1
    v_lshlrev_b32 v18, 4, v18
    v_bfe_u32 v21, v1, 4, 1
    v_mul_u32_u24 v21, 20480, v21
    v_add_u32 v18, v18, v21
    s_mul_i32 s14, s12, 5
    v_lshrrev_b32 v21, 5, v1
    v_add_u32 v21, s14, v21
    v_add_u32 v22, 0, v21
    v_lshrrev_b32 v8, 3, v22
    v_lshlrev_b32 v8, 10, v8
    v_and_b32 v23, 3, v22
    v_lshl_add_u32 v8, v23, 8, v8
    v_bfe_u32 v23, v22, 2, 1
    v_lshl_add_u32 v8, v23, 3, v8
    v_add_u32 v8, v8, v18
    v_add_u32 v22, 2, v21
    v_lshrrev_b32 v9, 3, v22
    v_lshlrev_b32 v9, 10, v9
    v_and_b32 v23, 3, v22
    v_lshl_add_u32 v9, v23, 8, v9
    v_bfe_u32 v23, v22, 2, 1
    v_lshl_add_u32 v9, v23, 3, v9
    v_add_u32 v9, v9, v18
    v_add_u32 v22, 4, v21
    v_lshrrev_b32 v10, 3, v22
    v_lshlrev_b32 v10, 10, v10
    v_and_b32 v23, 3, v22
    v_lshl_add_u32 v10, v23, 8, v10
    v_bfe_u32 v23, v22, 2, 1
    v_lshl_add_u32 v10, v23, 3, v10
    v_add_u32 v10, v10, v18
    v_cmp_gt_u32 vcc, 32, v1
    v_mov_b32 v23, 0x7ffffff0
    s_nop 0
    v_cndmask_b32 v10, v23, v10, vcc
    v_mov_b32 v132, 0
    v_mov_b32 v133, 0
    v_mov_b32 v134, 0
    v_mov_b32 v135, 0
    v_mov_b32 v136, 0
    v_mov_b32 v137, 0
    v_mov_b32 v138, 0
    v_mov_b32 v139, 0
    v_mov_b32 v140, 0
    v_mov_b32 v141, 0
    v_mov_b32 v142, 0
    v_mov_b32 v143, 0
    v_mov_b32 v144, 0
    v_mov_b32 v145, 0
    v_mov_b32 v146, 0
    v_mov_b32 v147, 0
    v_mov_b32 v148, 0
    v_mov_b32 v149, 0
    v_mov_b32 v150, 0
    v_mov_b32 v151, 0
    v_mov_b32 v152, 0
    v_mov_b32 v153, 0
    v_mov_b32 v154, 0
    v_mov_b32 v155, 0
    v_mov_b32 v156, 0
    v_mov_b32 v157, 0
    v_mov_b32 v158, 0
    v_mov_b32 v159, 0
    v_mov_b32 v160, 0
    v_mov_b32 v161, 0
    v_mov_b32 v162, 0
    v_mov_b32 v163, 0
    v_mov_b32 v130, 0
    v_mov_b32 v131, 0
    v_mov_b32 v64, 0
    v_mov_b32 v48, 0
    v_mov_b32 v65, 0
    v_mov_b32 v49, 0
    v_mov_b32 v66, 0
    v_mov_b32 v50, 0
    v_mov_b32 v67, 0
    v_mov_b32 v51, 0
    s_cmp_lt_u32 s8, 4
    s_cbranch_scc1 L_nz_50
    s_mul_i32 s38, s56, 52429
    s_lshr_b32 s38, s38, 22
    s_min_u32 s38, s38, 7
    s_add_u32 s38, s38, 24
    s_lshl_b32 s38, s38, 8
    s_add_u32 s38, s38, 50331648
    s_and_b32 s39, s59, 1
    s_cmp_eq_u32 s39, 0
    s_cbranch_scc1 L_nz_50
    buffer_store_dwordx2 v[224:225], v240, s[4:7], s62 offen offset:0 sc1
    buffer_store_dwordx2 v[226:227], v240, s[4:7], s62 offen offset:512 sc1
    buffer_store_dwordx2 v[228:229], v240, s[4:7], s62 offen offset:1024 sc1
    buffer_store_dwordx2 v[230:231], v240, s[4:7], s62 offen offset:1536 sc1
    buffer_store_dwordx2 v[232:233], v240, s[4:7], s62 offen offset:2048 sc1
    buffer_store_dwordx2 v[234:235], v240, s[4:7], s62 offen offset:2560 sc1
    buffer_store_dwordx2 v[236:237], v240, s[4:7], s62 offen offset:3072 sc1
    buffer_store_dwordx2 v[238:239], v240, s[4:7], s62 offen offset:3584 sc1
    s_waitcnt vmcnt(10) lgkmcnt(0)
    s_branch L_nz2_51
L_nz_50:
    s_waitcnt vmcnt(2) lgkmcnt(0)
L_nz2_51:
    v_cmp_gt_u32 vcc, 32, v1
    s_nop 1
    v_cndmask_b32 v36, 0, v36, vcc
    v_cndmask_b32 v37, 0, v37, vcc
    v_cndmask_b32 v38, 0, v38, vcc
    v_cndmask_b32 v39, 0, v39, vcc
    s_barrier
    ds_read_b64 v[32:33], v4 offset:0
    ds_read_b64 v[34:35], v4 offset:1056
    ds_read_b64 v[40:41], v5 offset:0
    s_waitcnt lgkmcnt(0)
    v_mfma_f32_32x32x16_bf16 v[68:83], v[32:35], v[24:27], 0
    v_mfma_f32_32x32x8_bf16 v[68:83], v[40:41], v[36:37], v[68:83]
    v_mfma_f32_32x32x16_bf16 v[84:99], v[32:35], v[28:31], 0
    v_mfma_f32_32x32x8_bf16 v[84:99], v[40:41], v[38:39], v[84:99]
    ds_read_b64 v[32:33], v4 offset:256
    ds_read_b64 v[34:35], v4 offset:1312
    ds_read_b64 v[40:41], v5 offset:256
    ds_read_b64_tr_b16 v[44:45], v6 offset:0
    ds_read_b64_tr_b16 v[46:47], v6 offset:64
    s_waitcnt lgkmcnt(0)
    s_nop 7
    s_cmp_ge_u32 s8, 4
    s_cbranch_scc1 L_attn_grpB
    s_setprio 2
    .p2align 6
L_attn_loopA:
    s_waitcnt lgkmcnt(3)
    v_mfma_f32_32x32x16_bf16 v[100:115], v[32:35], v[24:27], 0
    v_exp_f32 v68, v68
    v_cvt_pk_bf16_f32 v67, v130, v131
    v_exp_f32 v69, v69
    v_exp_f32 v70, v70
    v_cvt_pk_bf16_f32 v52, v68, v69
    v_exp_f32 v71, v71
    v_mfma_f32_32x32x16_bf16 v[148:163], v[48:51], v[64:67], v[148:163]
    ds_read_b64_tr_b16 v[48:49], v6 offset:128
    ds_read_b64_tr_b16 v[50:51], v6 offset:192
    v_exp_f32 v72, v72
    v_cvt_pk_bf16_f32 v53, v70, v71
    v_exp_f32 v73, v73
    v_exp_f32 v74, v74
    v_cvt_pk_bf16_f32 v54, v72, v73
    v_exp_f32 v75, v75
    v_mfma_f32_32x32x16_bf16 v[116:131], v[32:35], v[28:31], 0
    ds_read_b64 v[32:33], v4 offset:512
    ds_read_b64 v[34:35], v4 offset:1568
    s_add_u32 s14, s29, s32
    s_add_u32 m0, s14, 25344
    s_add_u32 s26, s26, 1024
    s_sub_u32 s14, s26, 1024
    buffer_load_dwordx4 v17, s[4:7], s14 offen lds
    v_exp_f32 v76, v76
    v_cvt_pk_bf16_f32 v55, v74, v75
    v_exp_f32 v77, v77
    v_exp_f32 v78, v78
    v_cvt_pk_bf16_f32 v56, v76, v77
    v_exp_f32 v79, v79
    s_waitcnt lgkmcnt(4)
    v_mfma_f32_32x32x16_bf16 v[132:147], v[44:47], v[52:55], v[132:147]
    v_exp_f32 v80, v80
    v_cvt_pk_bf16_f32 v57, v78, v79
    v_exp_f32 v81, v81
    v_exp_f32 v82, v82
    v_cvt_pk_bf16_f32 v58, v80, v81
    v_exp_f32 v83, v83
    v_mfma_f32_32x32x8_bf16 v[100:115], v[40:41], v[36:37], v[100:115]
    v_exp_f32 v84, v84
    v_cvt_pk_bf16_f32 v59, v82, v83
    v_exp_f32 v85, v85
    v_exp_f32 v86, v86
    v_cvt_pk_bf16_f32 v60, v84, v85
    v_exp_f32 v87, v87
    s_waitcnt lgkmcnt(2)
    v_mfma_f32_32x32x16_bf16 v[132:147], v[48:51], v[56:59], v[132:147]
    v_exp_f32 v88, v88
    v_cvt_pk_bf16_f32 v61, v86, v87
    v_exp_f32 v89, v89
    v_exp_f32 v90, v90
    v_cvt_pk_bf16_f32 v62, v88, v89
    v_exp_f32 v91, v91
    v_mfma_f32_32x32x8_bf16 v[116:131], v[40:41], v[38:39], v[116:131]
    ds_read_b64 v[40:41], v5 offset:512
    v_exp_f32 v92, v92
    v_cvt_pk_bf16_f32 v63, v90, v91
    v_exp_f32 v93, v93
    v_exp_f32 v94, v94
    v_cvt_pk_bf16_f32 v64, v92, v93
    v_exp_f32 v95, v95
    v_mfma_f32_32x32x16_bf16 v[148:163], v[44:47], v[60:63], v[148:163]
    ds_read_b64_tr_b16 v[44:45], v6 offset:256
    ds_read_b64_tr_b16 v[46:47], v6 offset:320
    v_exp_f32 v96, v96
    v_cvt_pk_bf16_f32 v65, v94, v95
    v_exp_f32 v97, v97
    v_exp_f32 v98, v98
    v_cvt_pk_bf16_f32 v66, v96, v97
    v_exp_f32 v99, v99
    s_setprio 0
    s_waitcnt lgkmcnt(3)
    v_mfma_f32_32x32x16_bf16 v[68:83], v[32:35], v[24:27], 0
    v_exp_f32 v100, v100
    v_cvt_pk_bf16_f32 v67, v98, v99
    v_exp_f32 v101, v101
    v_exp_f32 v102, v102
    v_cvt_pk_bf16_f32 v52, v100, v101
    v_exp_f32 v103, v103
    v_mfma_f32_32x32x16_bf16 v[148:163], v[48:51], v[64:67], v[148:163]
    ds_read_b64_tr_b16 v[48:49], v6 offset:384
    ds_read_b64_tr_b16 v[50:51], v6 offset:448
    v_exp_f32 v104, v104
    v_cvt_pk_bf16_f32 v53, v102, v103
    v_exp_f32 v105, v105
    v_exp_f32 v106, v106
    v_cvt_pk_bf16_f32 v54, v104, v105
    v_exp_f32 v107, v107
    v_mfma_f32_32x32x16_bf16 v[84:99], v[32:35], v[28:31], 0
    ds_read_b64 v[32:33], v4 offset:768
    ds_read_b64 v[34:35], v4 offset:1824
    v_exp_f32 v108, v108
    v_cvt_pk_bf16_f32 v55, v106, v107
    v_exp_f32 v109, v109
    v_exp_f32 v110, v110
    v_cvt_pk_bf16_f32 v56, v108, v109
    v_exp_f32 v111, v111
    s_waitcnt lgkmcnt(4)
    v_mfma_f32_32x32x16_bf16 v[132:147], v[44:47], v[52:55], v[132:147]
    v_exp_f32 v112, v112
    v_cvt_pk_bf16_f32 v57, v110, v111
    v_exp_f32 v113, v113
    v_exp_f32 v114, v114
    v_cvt_pk_bf16_f32 v58, v112, v113
    v_exp_f32 v115, v115
    v_mfma_f32_32x32x8_bf16 v[68:83], v[40:41], v[36:37], v[68:83]
    v_exp_f32 v116, v116
    v_cvt_pk_bf16_f32 v59, v114, v115
    v_exp_f32 v117, v117
    v_exp_f32 v118, v118
    v_cvt_pk_bf16_f32 v60, v116, v117
    v_exp_f32 v119, v119
    s_waitcnt lgkmcnt(2)
    v_mfma_f32_32x32x16_bf16 v[132:147], v[48:51], v[56:59], v[132:147]
    v_exp_f32 v120, v120
    v_cvt_pk_bf16_f32 v61, v118, v119
    v_exp_f32 v121, v121
    v_exp_f32 v122, v122
    v_cvt_pk_bf16_f32 v62, v120, v121
    v_exp_f32 v123, v123
    v_mfma_f32_32x32x8_bf16 v[84:99], v[40:41], v[38:39], v[84:99]
    ds_read_b64 v[40:41], v5 offset:768
    v_exp_f32 v124, v124
    v_cvt_pk_bf16_f32 v63, v122, v123
    v_exp_f32 v125, v125
    v_exp_f32 v126, v126
    v_cvt_pk_bf16_f32 v64, v124, v125
    v_exp_f32 v127, v127
    v_mfma_f32_32x32x16_bf16 v[148:163], v[44:47], v[60:63], v[148:163]
    ds_read_b64_tr_b16 v[44:45], v6 offset:512
    ds_read_b64_tr_b16 v[46:47], v6 offset:576
    v_exp_f32 v128, v128
    v_cvt_pk_bf16_f32 v65, v126, v127
    v_exp_f32 v129, v129
    v_exp_f32 v130, v130
    v_cvt_pk_bf16_f32 v66, v128, v129
    v_exp_f32 v131, v131
    s_waitcnt lgkmcnt(3)
    v_mfma_f32_32x32x16_bf16 v[100:115], v[32:35], v[24:27], 0
    v_exp_f32 v68, v68
    v_cvt_pk_bf16_f32 v67, v130, v131
    v_exp_f32 v69, v69
    v_exp_f32 v70, v70
    v_cvt_pk_bf16_f32 v52, v68, v69
    v_exp_f32 v71, v71
    v_mfma_f32_32x32x16_bf16 v[148:163], v[48:51], v[64:67], v[148:163]
    ds_read_b64_tr_b16 v[48:49], v6 offset:640
    ds_read_b64_tr_b16 v[50:51], v6 offset:704
    v_exp_f32 v72, v72
    v_cvt_pk_bf16_f32 v53, v70, v71
    v_exp_f32 v73, v73
    v_exp_f32 v74, v74
    v_cvt_pk_bf16_f32 v54, v72, v73
    v_exp_f32 v75, v75
    v_mfma_f32_32x32x16_bf16 v[116:131], v[32:35], v[28:31], 0
    s_waitcnt vmcnt(0)
    s_barrier
    s_setprio 2
    ds_read_b64 v[32:33], v4 offset:25344
    ds_read_b64 v[34:35], v4 offset:26400
    s_cmp_eq_u32 s19, 3
    s_cbranch_scc1 L_nd_52
    s_add_u32 s14, s27, s13
    s_mov_b32 m0, s14
    s_add_u32 s24, s24, 1024
    s_sub_u32 s14, s24, 1024
    buffer_load_dwordx4 v17, s[4:7], s14 offen lds
L_nd_52:
    v_exp_f32 v76, v76
    v_cvt_pk_bf16_f32 v55, v74, v75
    v_exp_f32 v77, v77
    v_exp_f32 v78, v78
    v_cvt_pk_bf16_f32 v56, v76, v77
    v_exp_f32 v79, v79
    s_waitcnt lgkmcnt(4)
    v_mfma_f32_32x32x16_bf16 v[132:147], v[44:47], v[52:55], v[132:147]
    v_exp_f32 v80, v80
    v_cvt_pk_bf16_f32 v57, v78, v79
    v_exp_f32 v81, v81
    v_exp_f32 v82, v82
    v_cvt_pk_bf16_f32 v58, v80, v81
    v_exp_f32 v83, v83
    v_mfma_f32_32x32x8_bf16 v[100:115], v[40:41], v[36:37], v[100:115]
    v_exp_f32 v84, v84
    v_cvt_pk_bf16_f32 v59, v82, v83
    v_exp_f32 v85, v85
    v_exp_f32 v86, v86
    v_cvt_pk_bf16_f32 v60, v84, v85
    v_exp_f32 v87, v87
    s_waitcnt lgkmcnt(2)
    v_mfma_f32_32x32x16_bf16 v[132:147], v[48:51], v[56:59], v[132:147]
    v_exp_f32 v88, v88
    v_cvt_pk_bf16_f32 v61, v86, v87
    v_exp_f32 v89, v89
    v_exp_f32 v90, v90
    v_cvt_pk_bf16_f32 v62, v88, v89
    v_exp_f32 v91, v91
    v_mfma_f32_32x32x8_bf16 v[116:131], v[40:41], v[38:39], v[116:131]
    ds_read_b64 v[40:41], v5 offset:25344
    v_exp_f32 v92, v92
    v_cvt_pk_bf16_f32 v63, v90, v91
    v_exp_f32 v93, v93
    v_exp_f32 v94, v94
    v_cvt_pk_bf16_f32 v64, v92, v93
    v_exp_f32 v95, v95
    v_mfma_f32_32x32x16_bf16 v[148:163], v[44:47], v[60:63], v[148:163]
    ds_read_b64_tr_b16 v[44:45], v6 offset:768
    ds_read_b64_tr_b16 v[46:47], v6 offset:832
    v_exp_f32 v96, v96
    v_cvt_pk_bf16_f32 v65, v94, v95
    v_exp_f32 v97, v97
    v_exp_f32 v98, v98
    v_cvt_pk_bf16_f32 v66, v96, v97
    v_exp_f32 v99, v99
    s_waitcnt lgkmcnt(3)
    v_mfma_f32_32x32x16_bf16 v[68:83], v[32:35], v[24:27], 0
    v_exp_f32 v100, v100
    v_cvt_pk_bf16_f32 v67, v98, v99
    v_exp_f32 v101, v101
    v_exp_f32 v102, v102
    v_cvt_pk_bf16_f32 v52, v100, v101
    v_exp_f32 v103, v103
    v_mfma_f32_32x32x16_bf16 v[148:163], v[48:51], v[64:67], v[148:163]
    ds_read_b64_tr_b16 v[48:49], v6 offset:896
    ds_read_b64_tr_b16 v[50:51], v6 offset:960
    v_exp_f32 v104, v104
    v_cvt_pk_bf16_f32 v53, v102, v103
    v_exp_f32 v105, v105
    v_exp_f32 v106, v106
    v_cvt_pk_bf16_f32 v54, v104, v105
    v_exp_f32 v107, v107
    v_mfma_f32_32x32x16_bf16 v[84:99], v[32:35], v[28:31], 0
    ds_read_b64 v[32:33], v4 offset:25600
    ds_read_b64 v[34:35], v4 offset:26656
    s_cmp_eq_u32 s19, 3
    s_cbranch_scc1 L_nd_53
    s_add_u32 s14, s28, s13
    s_mov_b32 m0, s14
    s_add_u32 s25, s25, 1024
    s_sub_u32 s14, s25, 1024
    buffer_load_dwordx4 v17, s[4:7], s14 offen lds
L_nd_53:
    v_exp_f32 v108, v108
    v_cvt_pk_bf16_f32 v55, v106, v107
    v_exp_f32 v109, v109
    v_exp_f32 v110, v110
    v_cvt_pk_bf16_f32 v56, v108, v109
    v_exp_f32 v111, v111
    s_waitcnt lgkmcnt(4)
    v_mfma_f32_32x32x16_bf16 v[132:147], v[44:47], v[52:55], v[132:147]
    v_exp_f32 v112, v112
    v_cvt_pk_bf16_f32 v57, v110, v111
    v_exp_f32 v113, v113
    v_exp_f32 v114, v114
    v_cvt_pk_bf16_f32 v58, v112, v113
    v_exp_f32 v115, v115
    v_mfma_f32_32x32x8_bf16 v[68:83], v[40:41], v[36:37], v[68:83]
    v_exp_f32 v116, v116
    v_cvt_pk_bf16_f32 v59, v114, v115
    v_exp_f32 v117, v117
    v_exp_f32 v118, v118
    v_cvt_pk_bf16_f32 v60, v116, v117
    v_exp_f32 v119, v119
    s_waitcnt lgkmcnt(2)
    v_mfma_f32_32x32x16_bf16 v[132:147], v[48:51], v[56:59], v[132:147]
    v_exp_f32 v120, v120
    v_cvt_pk_bf16_f32 v61, v118, v119
    v_exp_f32 v121, v121
    v_exp_f32 v122, v122
    v_cvt_pk_bf16_f32 v62, v120, v121
    v_exp_f32 v123, v123
    v_mfma_f32_32x32x8_bf16 v[84:99], v[40:41], v[38:39], v[84:99]
    ds_read_b64 v[40:41], v5 offset:25600
    v_exp_f32 v124, v124
    v_cvt_pk_bf16_f32 v63, v122, v123
    v_exp_f32 v125, v125
    v_exp_f32 v126, v126
    v_cvt_pk_bf16_f32 v64, v124, v125
    v_exp_f32 v127, v127
    v_mfma_f32_32x32x16_bf16 v[148:163], v[44:47], v[60:63], v[148:163]
    ds_read_b64_tr_b16 v[44:45], v6 offset:25344
    ds_read_b64_tr_b16 v[46:47], v6 offset:25408
    v_exp_f32 v128, v128
    v_cvt_pk_bf16_f32 v65, v126, v127
    v_exp_f32 v129, v129
    v_exp_f32 v130, v130
    v_cvt_pk_bf16_f32 v66, v128, v129
    v_exp_f32 v131, v131
    s_waitcnt lgkmcnt(3)
    v_mfma_f32_32x32x16_bf16 v[100:115], v[32:35], v[24:27], 0
    v_exp_f32 v68, v68
    v_cvt_pk_bf16_f32 v67, v130, v131
    v_exp_f32 v69, v69
    v_exp_f32 v70, v70
    v_cvt_pk_bf16_f32 v52, v68, v69
    v_exp_f32 v71, v71
    v_mfma_f32_32x32x16_bf16 v[148:163], v[48:51], v[64:67], v[148:163]
    ds_read_b64_tr_b16 v[48:49], v6 offset:25472
    ds_read_b64_tr_b16 v[50:51], v6 offset:25536
    v_exp_f32 v72, v72
    v_cvt_pk_bf16_f32 v53, v70, v71
    v_exp_f32 v73, v73
    v_exp_f32 v74, v74
    v_cvt_pk_bf16_f32 v54, v72, v73
    v_exp_f32 v75, v75
    v_mfma_f32_32x32x16_bf16 v[116:131], v[32:35], v[28:31], 0
    ds_read_b64 v[32:33], v4 offset:25856
    ds_read_b64 v[34:35], v4 offset:26912
    s_cmp_eq_u32 s19, 3
    s_cbranch_scc1 L_nd_54
    s_add_u32 s14, s29, s13
    s_mov_b32 m0, s14
    s_add_u32 s26, s26, 1024
    s_sub_u32 s14, s26, 1024
    buffer_load_dwordx4 v17, s[4:7], s14 offen lds
L_nd_54:
    v_exp_f32 v76, v76
    v_cvt_pk_bf16_f32 v55, v74, v75
    v_exp_f32 v77, v77
    v_exp_f32 v78, v78
    v_cvt_pk_bf16_f32 v56, v76, v77
    v_exp_f32 v79, v79
    s_waitcnt lgkmcnt(4)
    v_mfma_f32_32x32x16_bf16 v[132:147], v[44:47], v[52:55], v[132:147]
    v_exp_f32 v80, v80
    v_cvt_pk_bf16_f32 v57, v78, v79
    v_exp_f32 v81, v81
    v_exp_f32 v82, v82
    v_cvt_pk_bf16_f32 v58, v80, v81
    v_exp_f32 v83, v83
    v_mfma_f32_32x32x8_bf16 v[100:115], v[40:41], v[36:37], v[100:115]
    v_exp_f32 v84, v84
    v_cvt_pk_bf16_f32 v59, v82, v83
    v_exp_f32 v85, v85
    v_exp_f32 v86, v86
    v_cvt_pk_bf16_f32 v60, v84, v85
    v_exp_f32 v87, v87
    s_waitcnt lgkmcnt(2)
    v_mfma_f32_32x32x16_bf16 v[132:147], v[48:51], v[56:59], v[132:147]
    v_exp_f32 v88, v88
    v_cvt_pk_bf16_f32 v61, v86, v87
    v_exp_f32 v89, v89
    v_exp_f32 v90, v90
    v_cvt_pk_bf16_f32 v62, v88, v89
    v_exp_f32 v91, v91
    v_mfma_f32_32x32x8_bf16 v[116:131], v[40:41], v[38:39], v[116:131]
    ds_read_b64 v[40:41], v5 offset:25856
    v_exp_f32 v92, v92
    v_cvt_pk_bf16_f32 v63, v90, v91
    v_exp_f32 v93, v93
    v_exp_f32 v94, v94
    v_cvt_pk_bf16_f32 v64, v92, v93
    v_exp_f32 v95, v95
    v_mfma_f32_32x32x16_bf16 v[148:163], v[44:47], v[60:63], v[148:163]
    ds_read_b64_tr_b16 v[44:45], v6 offset:25600
    ds_read_b64_tr_b16 v[46:47], v6 offset:25664
    v_exp_f32 v96, v96
    v_cvt_pk_bf16_f32 v65, v94, v95
    v_exp_f32 v97, v97
    v_exp_f32 v98, v98
    v_cvt_pk_bf16_f32 v66, v96, v97
    v_exp_f32 v99, v99
    s_setprio 0
    s_waitcnt lgkmcnt(3)
    v_mfma_f32_32x32x16_bf16 v[68:83], v[32:35], v[24:27], 0
    v_exp_f32 v100, v100
    v_cvt_pk_bf16_f32 v67, v98, v99
    v_exp_f32 v101, v101
    v_exp_f32 v102, v102
    v_cvt_pk_bf16_f32 v52, v100, v101
    v_exp_f32 v103, v103
    v_mfma_f32_32x32x16_bf16 v[148:163], v[48:51], v[64:67], v[148:163]
    ds_read_b64_tr_b16 v[48:49], v6 offset:25728
    ds_read_b64_tr_b16 v[50:51], v6 offset:25792
    v_exp_f32 v104, v104
    v_cvt_pk_bf16_f32 v53, v102, v103
    v_exp_f32 v105, v105
    v_exp_f32 v106, v106
    v_cvt_pk_bf16_f32 v54, v104, v105
    v_exp_f32 v107, v107
    v_mfma_f32_32x32x16_bf16 v[84:99], v[32:35], v[28:31], 0
    ds_read_b64 v[32:33], v4 offset:26112
    ds_read_b64 v[34:35], v4 offset:27168
    buffer_load_dword v11, v12, s[4:7], s35 offen sc1
    v_exp_f32 v108, v108
    v_cvt_pk_bf16_f32 v55, v106, v107
    v_exp_f32 v109, v109
    v_exp_f32 v110, v110
    v_cvt_pk_bf16_f32 v56, v108, v109
    v_exp_f32 v111, v111
    s_waitcnt lgkmcnt(4)
    v_mfma_f32_32x32x16_bf16 v[132:147], v[44:47], v[52:55], v[132:147]
    v_exp_f32 v112, v112
    v_cvt_pk_bf16_f32 v57, v110, v111
    v_exp_f32 v113, v113
    v_exp_f32 v114, v114
    v_cvt_pk_bf16_f32 v58, v112, v113
    v_exp_f32 v115, v115
    v_mfma_f32_32x32x8_bf16 v[68:83], v[40:41], v[36:37], v[68:83]
    v_exp_f32 v116, v116
    v_cvt_pk_bf16_f32 v59, v114, v115
    v_exp_f32 v117, v117
    v_exp_f32 v118, v118
    v_cvt_pk_bf16_f32 v60, v116, v117
    v_exp_f32 v119, v119
    s_waitcnt lgkmcnt(2)
    v_mfma_f32_32x32x16_bf16 v[132:147], v[48:51], v[56:59], v[132:147]
    v_exp_f32 v120, v120
    v_cvt_pk_bf16_f32 v61, v118, v119
    v_exp_f32 v121, v121
    v_exp_f32 v122, v122
    v_cvt_pk_bf16_f32 v62, v120, v121
    v_exp_f32 v123, v123
    v_mfma_f32_32x32x8_bf16 v[84:99], v[40:41], v[38:39], v[84:99]
    ds_read_b64 v[40:41], v5 offset:26112
    v_exp_f32 v124, v124
    v_cvt_pk_bf16_f32 v63, v122, v123
    v_exp_f32 v125, v125
    v_exp_f32 v126, v126
    v_cvt_pk_bf16_f32 v64, v124, v125
    v_exp_f32 v127, v127
    v_mfma_f32_32x32x16_bf16 v[148:163], v[44:47], v[60:63], v[148:163]
    ds_read_b64_tr_b16 v[44:45], v6 offset:25856
    ds_read_b64_tr_b16 v[46:47], v6 offset:25920
    v_exp_f32 v128, v128
    v_cvt_pk_bf16_f32 v65, v126, v127
    v_exp_f32 v129, v129
    v_exp_f32 v130, v130
    v_cvt_pk_bf16_f32 v66, v128, v129
    v_exp_f32 v131, v131
    s_waitcnt lgkmcnt(3)
    v_mfma_f32_32x32x16_bf16 v[100:115], v[32:35], v[24:27], 0
    v_exp_f32 v68, v68
    v_cvt_pk_bf16_f32 v67, v130, v131
    v_exp_f32 v69, v69
    v_exp_f32 v70, v70
    v_cvt_pk_bf16_f32 v52, v68, v69
    v_exp_f32 v71, v71
    v_mfma_f32_32x32x16_bf16 v[148:163], v[48:51], v[64:67], v[148:163]
    ds_read_b64_tr_b16 v[48:49], v6 offset:25984
    ds_read_b64_tr_b16 v[50:51], v6 offset:26048
    v_exp_f32 v72, v72
    v_cvt_pk_bf16_f32 v53, v70, v71
    v_exp_f32 v73, v73
    v_exp_f32 v74, v74
    v_cvt_pk_bf16_f32 v54, v72, v73
    v_exp_f32 v75, v75
    v_mfma_f32_32x32x16_bf16 v[116:131], v[32:35], v[28:31], 0
    s_waitcnt vmcnt(0)
    s_barrier
    s_setprio 2
    v_add_u32 v4, s30, v4
    v_add_u32 v5, s30, v5
    ds_read_b64 v[32:33], v4 offset:0
    ds_read_b64 v[34:35], v4 offset:1056
    s_cmp_eq_u32 s19, 3
    s_cbranch_scc1 L_weA
L_weA_ret:
    s_cmp_eq_u32 s19, 3
    s_cbranch_scc1 L_nd_55
    s_add_u32 s14, s27, s13
    s_add_u32 m0, s14, 25344
    s_add_u32 s24, s24, 1024
    s_sub_u32 s14, s24, 1024
    buffer_load_dwordx4 v17, s[4:7], s14 offen lds
L_nd_55:
    v_exp_f32 v76, v76
    v_cvt_pk_bf16_f32 v55, v74, v75
    v_exp_f32 v77, v77
    v_exp_f32 v78, v78
    v_cvt_pk_bf16_f32 v56, v76, v77
    v_exp_f32 v79, v79
    s_waitcnt lgkmcnt(4)
    v_mfma_f32_32x32x16_bf16 v[132:147], v[44:47], v[52:55], v[132:147]
    v_exp_f32 v80, v80
    v_cvt_pk_bf16_f32 v57, v78, v79
    v_exp_f32 v81, v81
    v_exp_f32 v82, v82
    v_cvt_pk_bf16_f32 v58, v80, v81
    v_exp_f32 v83, v83
    v_mfma_f32_32x32x8_bf16 v[100:115], v[40:41], v[36:37], v[100:115]
    v_exp_f32 v84, v84
    v_cvt_pk_bf16_f32 v59, v82, v83
    v_exp_f32 v85, v85
    v_exp_f32 v86, v86
    v_cvt_pk_bf16_f32 v60, v84, v85
    v_exp_f32 v87, v87
    s_waitcnt lgkmcnt(2)
    v_mfma_f32_32x32x16_bf16 v[132:147], v[48:51], v[56:59], v[132:147]
    v_exp_f32 v88, v88
    v_cvt_pk_bf16_f32 v61, v86, v87
    v_exp_f32 v89, v89
    v_exp_f32 v90, v90
    v_cvt_pk_bf16_f32 v62, v88, v89
    v_exp_f32 v91, v91
    v_mfma_f32_32x32x8_bf16 v[116:131], v[40:41], v[38:39], v[116:131]
    ds_read_b64 v[40:41], v5 offset:0
    v_exp_f32 v92, v92
    v_cvt_pk_bf16_f32 v63, v90, v91
    v_exp_f32 v93, v93
    v_exp_f32 v94, v94
    v_cvt_pk_bf16_f32 v64, v92, v93
    v_exp_f32 v95, v95
    v_mfma_f32_32x32x16_bf16 v[148:163], v[44:47], v[60:63], v[148:163]
    ds_read_b64_tr_b16 v[44:45], v6 offset:26112
    ds_read_b64_tr_b16 v[46:47], v6 offset:26176
    v_exp_f32 v96, v96
    v_cvt_pk_bf16_f32 v65, v94, v95
    v_exp_f32 v97, v97
    v_exp_f32 v98, v98
    v_cvt_pk_bf16_f32 v66, v96, v97
    v_exp_f32 v99, v99
    s_waitcnt lgkmcnt(3)
    v_mfma_f32_32x32x16_bf16 v[68:83], v[32:35], v[24:27], 0
    v_exp_f32 v100, v100
    v_cvt_pk_bf16_f32 v67, v98, v99
    v_exp_f32 v101, v101
    v_exp_f32 v102, v102
    v_cvt_pk_bf16_f32 v52, v100, v101
    v_exp_f32 v103, v103
    v_mfma_f32_32x32x16_bf16 v[148:163], v[48:51], v[64:67], v[148:163]
    ds_read_b64_tr_b16 v[48:49], v6 offset:26240
    ds_read_b64_tr_b16 v[50:51], v6 offset:26304
    v_exp_f32 v104, v104
    v_cvt_pk_bf16_f32 v53, v102, v103
    v_exp_f32 v105, v105
    v_exp_f32 v106, v106
    v_cvt_pk_bf16_f32 v54, v104, v105
    v_exp_f32 v107, v107
    v_mfma_f32_32x32x16_bf16 v[84:99], v[32:35], v[28:31], 0
    ds_read_b64 v[32:33], v4 offset:256
    ds_read_b64 v[34:35], v4 offset:1312
    s_cmp_eq_u32 s19, 3
    s_cbranch_scc1 L_nd_56
    s_add_u32 s14, s28, s13
    s_add_u32 m0, s14, 25344
    s_add_u32 s25, s25, 1024
    s_sub_u32 s14, s25, 1024
    buffer_load_dwordx4 v17, s[4:7], s14 offen lds
L_nd_56:
    v_exp_f32 v108, v108
    v_cvt_pk_bf16_f32 v55, v106, v107
    v_exp_f32 v109, v109
    v_exp_f32 v110, v110
    v_cvt_pk_bf16_f32 v56, v108, v109
    v_exp_f32 v111, v111
    s_waitcnt lgkmcnt(4)
    v_mfma_f32_32x32x16_bf16 v[132:147], v[44:47], v[52:55], v[132:147]
    v_exp_f32 v112, v112
    v_cvt_pk_bf16_f32 v57, v110, v111
    v_exp_f32 v113, v113
    v_exp_f32 v114, v114
    v_cvt_pk_bf16_f32 v58, v112, v113
    v_exp_f32 v115, v115
    v_mfma_f32_32x32x8_bf16 v[68:83], v[40:41], v[36:37], v[68:83]
    v_exp_f32 v116, v116
    v_cvt_pk_bf16_f32 v59, v114, v115
    v_exp_f32 v117, v117
    v_exp_f32 v118, v118
    v_cvt_pk_bf16_f32 v60, v116, v117
    v_exp_f32 v119, v119
    s_waitcnt lgkmcnt(2)
    v_mfma_f32_32x32x16_bf16 v[132:147], v[48:51], v[56:59], v[132:147]
    v_exp_f32 v120, v120
    v_cvt_pk_bf16_f32 v61, v118, v119
    v_exp_f32 v121, v121
    v_exp_f32 v122, v122
    v_cvt_pk_bf16_f32 v62, v120, v121
    v_exp_f32 v123, v123
    v_mfma_f32_32x32x8_bf16 v[84:99], v[40:41], v[38:39], v[84:99]
    ds_read_b64 v[40:41], v5 offset:256
    v_add_u32 v6, s30, v6
    v_exp_f32 v124, v124
    v_cvt_pk_bf16_f32 v63, v122, v123
    v_exp_f32 v125, v125
    v_exp_f32 v126, v126
    v_cvt_pk_bf16_f32 v64, v124, v125
    v_exp_f32 v127, v127
    v_mfma_f32_32x32x16_bf16 v[148:163], v[44:47], v[60:63], v[148:163]
    ds_read_b64_tr_b16 v[44:45], v6 offset:0
    ds_read_b64_tr_b16 v[46:47], v6 offset:64
    v_exp_f32 v128, v128
    v_cvt_pk_bf16_f32 v65, v126, v127
    v_exp_f32 v129, v129
    v_exp_f32 v130, v130
    v_cvt_pk_bf16_f32 v66, v128, v129
    v_exp_f32 v131, v131
    s_sub_u32 s30, 0, s30
    s_mov_b32 s14, s32
    s_mov_b32 s32, s13
    s_mov_b32 s13, s14
    s_add_u32 s19, s19, 1
    s_cmp_lt_u32 s19, 4
    s_cbranch_scc1 L_attn_loopA
L_attn_loopdone:
    v_cvt_pk_bf16_f32 v67, v130, v131
    s_waitcnt lgkmcnt(0)
    s_nop 1
    v_mfma_f32_32x32x16_bf16 v[148:163], v[48:51], v[64:67], v[148:163]
    s_setprio 0
    s_mul_i32 s14, s8, 3072
    s_add_u32 s14, s14, 102400
    v_add_u32 v20, s14, v17
    s_xor_b32 s14, s8, 4
    s_mul_i32 s14, s14, 3072
    s_add_u32 s14, s14, 102400
    v_add_u32 v19, s14, v17
    s_nop 12
    s_cmp_ge_u32 s8, 4
    s_cbranch_scc1 L_attn_xb
    ds_write_b128 v20, v[148:151] offset:0
    ds_write_b128 v20, v[152:155] offset:1024
    ds_write_b128 v20, v[156:159] offset:2048
    s_waitcnt vmcnt(0) lgkmcnt(0)
    s_barrier
    ds_read_b128 v[68:71], v19 offset:0
    ds_read_b128 v[72:75], v19 offset:1024
    ds_read_b128 v[76:79], v19 offset:2048
    s_waitcnt lgkmcnt(0)
    v_add_f32 v84, v132, v68
    v_add_f32 v85, v133, v69
    v_add_f32 v86, v134, v70
    v_add_f32 v87, v135, v71
    v_add_f32 v88, v136, v72
    v_add_f32 v89, v137, v73
    v_add_f32 v90, v138, v74
    v_add_f32 v91, v139, v75
    v_add_f32 v92, v140, v76
    v_add_f32 v93, v141, v77
    v_add_f32 v94, v142, v78
    v_add_f32 v95, v143, v79
    s_branch L_attn_xc
L_attn_xb:
    ds_write_b128 v20, v[132:135] offset:0
    ds_write_b128 v20, v[136:139] offset:1024
    ds_write_b128 v20, v[140:143] offset:2048
    s_waitcnt vmcnt(0) lgkmcnt(0)
    s_barrier
    ds_read_b128 v[68:71], v19 offset:0
    ds_read_b128 v[72:75], v19 offset:1024
    ds_read_b128 v[76:79], v19 offset:2048
    v_mov_b32 v24, v28
    v_mov_b32 v25, v29
    v_mov_b32 v26, v30
    v_mov_b32 v27, v31
    v_mov_b32 v36, v38
    v_mov_b32 v37, v39
    s_waitcnt lgkmcnt(0)
    v_add_f32 v84, v148, v68
    v_add_f32 v85, v149, v69
    v_add_f32 v86, v150, v70
    v_add_f32 v87, v151, v71
    v_add_f32 v88, v152, v72
    v_add_f32 v89, v153, v73
    v_add_f32 v90, v154, v74
    v_add_f32 v91, v155, v75
    v_add_f32 v92, v156, v76
    v_add_f32 v93, v157, v77
    v_add_f32 v94, v158, v78
    v_add_f32 v95, v159, v79
L_attn_xc:
    v_mov_b32 v19, v92
    v_mov_b32 v18, v92
    s_nop 1
    v_permlane32_swap_b32 v19, v18
    v_mul_f32 v19, 0, v84
    v_mul_f32 v21, 0, v85
    v_mul_f32 v22, 0, v86
    v_fma_f32 v19, v87, 0, v19
    v_fma_f32 v21, v88, 0, v21
    v_fma_f32 v22, v89, 0, v22
    v_fma_f32 v19, v90, 0, v19
    v_fma_f32 v21, v91, 0, v21
    v_fma_f32 v22, v92, 0, v22
    v_fma_f32 v19, v93, 0, v19
    v_fma_f32 v21, v94, 0, v21
    v_fma_f32 v22, v95, 0, v22
    v_add_f32 v19, v19, v21
    v_add_f32 v19, v19, v22
    s_mov_b32 s14, 0x12800000
    s_mov_b32 s15, 0x6c800000
    v_cmp_le_f32 s[20:21], s14, v18
    v_cmp_ge_f32 s[22:23], s15, v18
    v_cmp_o_f32 vcc, v19, v19
    s_nop 1
    s_and_b64 s[20:21], s[20:21], s[22:23]
    s_and_b64 s[20:21], s[20:21], vcc
    s_cmp_eq_u64 s[20:21], -1
    s_cbranch_scc0 L_attn_slow
L_attn_fin:
    v_rcp_f32 v18, v18
    s_nop 0
    v_mul_f32 v84, v84, v18
    v_mul_f32 v85, v85, v18
    v_mul_f32 v86, v86, v18
    v_mul_f32 v87, v87, v18
    v_mul_f32 v88, v88, v18
    v_mul_f32 v89, v89, v18
    v_mul_f32 v90, v90, v18
    v_mul_f32 v91, v91, v18
    v_mul_f32 v92, v92, v18
    v_mul_f32 v93, v93, v18
    v_mul_f32 v94, v94, v18
    v_mul_f32 v95, v95, v18
    v_cvt_pk_bf16_f32 v52, v84, v85
    v_cvt_pk_bf16_f32 v53, v86, v87
    v_cvt_pk_bf16_f32 v54, v88, v89
    v_cvt_pk_bf16_f32 v55, v90, v91
    v_cvt_pk_bf16_f32 v56, v92, v93
    v_cvt_pk_bf16_f32 v57, v94, v95
    v_cmp_le_u32 vcc, v13, v11
    s_nop 1
    s_cmp_eq_u64 vcc, exec
    s_cbranch_scc0 L_wnok_63
L_wok_62:
    v_min_u32 v52, 0xfffeffff, v52
    v_min_u32 v53, 0xfffeffff, v53
    v_min_u32 v54, 0xfffeffff, v54
    v_min_u32 v55, 0xfffeffff, v55
    v_min_u32 v56, 0xfffeffff, v56
    v_min_u32 v57, 0xfffeffff, v57
    buffer_store_dwordx2 v[52:53], v8, s[4:7], s34 offen sc1
    buffer_store_dwordx2 v[54:55], v9, s[4:7], s34 offen sc1
    buffer_store_dwordx2 v[56:57], v10, s[4:7], s34 offen sc1
    s_cmp_eq_u32 s57, 0
    s_cbranch_scc1 L_wl_66
L_wl2_67:
    s_cmp_ge_u32 s8, 4
    s_cbranch_scc1 L_tail_aux
    s_and_b32 s24, s2, 7
    s_lshl_b32 s24, s24, 2
    s_bfe_u32 s26, s2, 0x20003
    s_add_u32 s24, s24, s26
    s_lshr_b32 s25, s2, 5
    v_lshlrev_b32 v174, 4, v1
    s_mov_b32 s16, s82
    s_and_b32 s17, s83, 0xffff
    s_mov_b32 s18, 5242880
    s_mov_b32 s19, 0x20000
    v_mov_b32 v172, v174
    v_add_u32 v173, 51200, v174
    v_add_u32 v175, 126976, v174
    v_mov_b32 v152, 0
    v_mov_b32 v153, 0
    v_mov_b32 v154, 0
    v_mov_b32 v155, 0
    v_mov_b32 v156, 0
    v_mov_b32 v157, 0
    v_mov_b32 v158, 0
    v_mov_b32 v159, 0
    v_mov_b32 v160, 0
    v_mov_b32 v161, 0
    v_mov_b32 v162, 0
    v_mov_b32 v163, 0
    v_mov_b32 v164, 0
    v_mov_b32 v165, 0
    v_mov_b32 v166, 0
    v_mov_b32 v167, 0
    v_mov_b32 v168, 0
    v_mov_b32 v169, 0
    v_mov_b32 v170, 0
    v_mov_b32 v171, 0
    s_lshl_b32 s26, s24, 6
    s_lshl_b32 s27, s8, 4
    s_add_u32 s31, s26, s27
    v_add_u32 v4, 0, v1
    v_mul_u32_u24 v5, 6554, v4
    v_lshrrev_b32 v5, 16, v5
    v_mul_u32_u24 v7, 10, v5
    v_sub_u32 v6, v4, v7
    v_add_u32 v5, s31, v5
    v_mul_u32_u24 v176, 2560, v5
    v_lshl_add_u32 v176, v6, 4, v176
    v_add_u32 v4, 64, v1
    v_mul_u32_u24 v5, 6554, v4
    v_lshrrev_b32 v5, 16, v5
    v_mul_u32_u24 v7, 10, v5
    v_sub_u32 v6, v4, v7
    v_add_u32 v5, s31, v5
    v_mul_u32_u24 v177, 2560, v5
    v_lshl_add_u32 v177, v6, 4, v177
    v_add_u32 v4, 128, v1
    v_mul_u32_u24 v5, 6554, v4
    v_lshrrev_b32 v5, 16, v5
    v_mul_u32_u24 v7, 10, v5
    v_sub_u32 v6, v4, v7
    v_add_u32 v5, s31, v5
    v_mul_u32_u24 v178, 2560, v5
    v_lshl_add_u32 v178, v6, 4, v178
    s_mul_i32 s26, s8, 3072
    s_add_u32 s26, s26, 102400
    v_and_b32 v4, 15, v1
    v_mul_u32_u24 v179, 160, v4
    v_lshrrev_b32 v4, 4, v1
    v_lshl_add_u32 v179, v4, 3, v179
    v_add_u32 v179, s26, v179
    v_add_u32 v180, s26, v174
    s_lshr_b32 s26, s24, 2
    s_add_u32 s26, s26, 32
    s_lshl_b32 s26, s26, 8
    v_mov_b32 v4, s26
    v_mov_b32 v2, 163776
    v_mov_b32 v3, 1
    s_mov_b64 s[94:95], exec
    s_mov_b64 exec, 1
    ds_add_u32 v2, v3 offset:12
    s_mov_b64 exec, s[94:95]
    s_mov_b32 s92, 0
L_lc_68:
    ds_read_b32 v3, v2 offset:12
    s_add_u32 s92, s92, 1
    s_waitcnt lgkmcnt(0)
    v_readfirstlane_b32 s93, v3
    s_cmp_ge_u32 s93, 8
    s_cbranch_scc1 L_lcd_69
    s_cmp_lt_u32 s92, 2097152
    s_cbranch_scc1 L_lc_68
L_lcd_69:
    s_cmp_eq_u32 s8, 0
    s_cbranch_scc0 L_po_70
    v_and_b32 v4, 31, v1
    v_mul_u32_u24 v4, 5, v4
    v_add_u32 v4, 4, v4
    v_lshrrev_b32 v132, 3, v4
    v_lshlrev_b32 v132, 10, v132
    v_and_b32 v5, 3, v4
    v_lshl_add_u32 v132, v5, 8, v132
    v_bfe_u32 v5, v4, 2, 1
    v_lshl_add_u32 v132, v5, 3, v132
    v_lshrrev_b32 v5, 5, v1
    v_mul_u32_u24 v5, 40960, v5
    v_add_u32 v132, v132, v5
    s_mul_i32 s26, s24, 81920
    s_add_u32 s26, s26, 8388608
    s_mov_b32 s92, 0
L_lp_72:
    buffer_load_dwordx2 v[134:135], v132, s[4:7], s26 offen sc1
    s_add_u32 s92, s92, 1
    s_waitcnt vmcnt(0)
    v_cmp_eq_u32 vcc, -1, v134
    s_nop 1
    s_cmp_eq_u64 vcc, 0
    s_cbranch_scc1 L_lpd_73
    s_sleep 1
    s_cmp_lt_u32 s92, 131072
    s_cbranch_scc1 L_lp_72
L_lpd_73:
    v_mov_b32 v2, 163776
    v_mov_b32 v3, 1
    ds_write_b32 v2, v3 offset:4
    s_branch L_po2_71
L_po_70:
    v_mov_b32 v2, 163776
    s_mov_b32 s92, 0
L_lw_74:
    ds_read_b32 v3, v2 offset:4
    s_add_u32 s92, s92, 1
    s_waitcnt lgkmcnt(0)
    v_readfirstlane_b32 s93, v3
    s_cmp_lg_u32 s93, 0
    s_cbranch_scc1 L_lwd_75
    s_sleep 1
    s_cmp_lt_u32 s92, 2097152
    s_cbranch_scc1 L_lw_74
L_lwd_75:
L_po2_71:
    s_mov_b32 s32, 0
L_p3_retry:
    s_lshl_b32 s26, s24, 2
    s_add_u32 s26, s26, s8
    s_mul_i32 s26, s26, 20480
    s_add_u32 s26, s26, 8388608
    buffer_load_dwordx4 v[12:15], v174, s[4:7], s26 offen offset:0 sc1
    buffer_load_dwordx4 v[16:19], v174, s[4:7], s26 offen offset:1024 sc1
    buffer_load_dwordx4 v[20:23], v174, s[4:7], s26 offen offset:2048 sc1
    buffer_load_dwordx4 v[24:27], v174, s[4:7], s26 offen offset:3072 sc1
    s_add_u32 s26, s26, 4096
    buffer_load_dwordx4 v[28:31], v174, s[4:7], s26 offen offset:0 sc1
    buffer_load_dwordx4 v[32:35], v174, s[4:7], s26 offen offset:1024 sc1
    buffer_load_dwordx4 v[36:39], v174, s[4:7], s26 offen offset:2048 sc1
    buffer_load_dwordx4 v[40:43], v174, s[4:7], s26 offen offset:3072 sc1
    s_add_u32 s26, s26, 4096
    buffer_load_dwordx4 v[44:47], v174, s[4:7], s26 offen offset:0 sc1
    buffer_load_dwordx4 v[48:51], v174, s[4:7], s26 offen offset:1024 sc1
    buffer_load_dwordx4 v[52:55], v174, s[4:7], s26 offen offset:2048 sc1
    buffer_load_dwordx4 v[56:59], v174, s[4:7], s26 offen offset:3072 sc1
    s_add_u32 s26, s26, 4096
    buffer_load_dwordx4 v[60:63], v174, s[4:7], s26 offen offset:0 sc1
    buffer_load_dwordx4 v[64:67], v174, s[4:7], s26 offen offset:1024 sc1
    buffer_load_dwordx4 v[68:71], v174, s[4:7], s26 offen offset:2048 sc1
    buffer_load_dwordx4 v[72:75], v174, s[4:7], s26 offen offset:3072 sc1
    s_add_u32 s26, s26, 4096
    buffer_load_dwordx4 v[76:79], v174, s[4:7], s26 offen offset:0 sc1
    buffer_load_dwordx4 v[80:83], v174, s[4:7], s26 offen offset:1024 sc1
    buffer_load_dwordx4 v[84:87], v174, s[4:7], s26 offen offset:2048 sc1
    buffer_load_dwordx4 v[88:91], v174, s[4:7], s26 offen offset:3072 sc1
    v_mov_b32 v10, 0
    s_waitcnt lgkmcnt(0)
    ds_read_b128 v[92:95], v172 offset:0
    ds_read_b128 v[96:99], v172 offset:1024
    ds_read_b128 v[100:103], v172 offset:2048
    ds_read_b128 v[104:107], v172 offset:3072
    ds_read_b128 v[108:111], v172 offset:4096
    ds_read_b128 v[112:115], v172 offset:5120
    ds_read_b128 v[116:119], v172 offset:6144
    ds_read_b128 v[120:123], v172 offset:7168
    ds_read_b128 v[124:127], v172 offset:8192
    ds_read_b128 v[128:131], v172 offset:9216
    s_waitcnt lgkmcnt(5) vmcnt(19)
    v_mfma_f32_16x16x32_bf16 v[152:155], v[92:95], v[12:15], v[152:155]
    ds_read_b128 v[132:135], v172 offset:10240
    v_mfma_f32_16x16x32_bf16 v[156:159], v[96:99], v[12:15], v[156:159]
    ds_read_b128 v[136:139], v172 offset:11264
    v_max3_u32 v10, v12, v13, v10
    v_mfma_f32_16x16x32_bf16 v[160:163], v[100:103], v[12:15], v[160:163]
    ds_read_b128 v[140:143], v172 offset:12288
    v_mfma_f32_16x16x32_bf16 v[164:167], v[104:107], v[12:15], v[164:167]
    ds_read_b128 v[144:147], v172 offset:13312
    v_max3_u32 v10, v14, v15, v10
    v_mfma_f32_16x16x32_bf16 v[168:171], v[108:111], v[12:15], v[168:171]
    ds_read_b128 v[148:151], v172 offset:14336
    s_waitcnt lgkmcnt(5) vmcnt(18)
    v_mfma_f32_16x16x32_bf16 v[152:155], v[112:115], v[16:19], v[152:155]
    ds_read_b128 v[92:95], v172 offset:15360
    v_mfma_f32_16x16x32_bf16 v[156:159], v[116:119], v[16:19], v[156:159]
    ds_read_b128 v[96:99], v172 offset:16384
    v_max3_u32 v10, v16, v17, v10
    v_mfma_f32_16x16x32_bf16 v[160:163], v[120:123], v[16:19], v[160:163]
    ds_read_b128 v[100:103], v172 offset:17408
    v_mfma_f32_16x16x32_bf16 v[164:167], v[124:127], v[16:19], v[164:167]
    ds_read_b128 v[104:107], v172 offset:18432
    v_max3_u32 v10, v18, v19, v10
    v_mfma_f32_16x16x32_bf16 v[168:171], v[128:131], v[16:19], v[168:171]
    ds_read_b128 v[108:111], v172 offset:19456
    s_waitcnt lgkmcnt(5) vmcnt(17)
    v_mfma_f32_16x16x32_bf16 v[152:155], v[132:135], v[20:23], v[152:155]
    ds_read_b128 v[112:115], v172 offset:20480
    v_mfma_f32_16x16x32_bf16 v[156:159], v[136:139], v[20:23], v[156:159]
    ds_read_b128 v[116:119], v172 offset:21504
    v_max3_u32 v10, v20, v21, v10
    v_mfma_f32_16x16x32_bf16 v[160:163], v[140:143], v[20:23], v[160:163]
    ds_read_b128 v[120:123], v172 offset:22528
    v_mfma_f32_16x16x32_bf16 v[164:167], v[144:147], v[20:23], v[164:167]
    ds_read_b128 v[124:127], v172 offset:23552
    v_max3_u32 v10, v22, v23, v10
    v_mfma_f32_16x16x32_bf16 v[168:171], v[148:151], v[20:23], v[168:171]
    ds_read_b128 v[128:131], v172 offset:24576
    s_waitcnt lgkmcnt(5) vmcnt(16)
    v_mfma_f32_16x16x32_bf16 v[152:155], v[92:95], v[24:27], v[152:155]
    ds_read_b128 v[132:135], v172 offset:25600
    v_mfma_f32_16x16x32_bf16 v[156:159], v[96:99], v[24:27], v[156:159]
    ds_read_b128 v[136:139], v172 offset:26624
    v_max3_u32 v10, v24, v25, v10
    v_mfma_f32_16x16x32_bf16 v[160:163], v[100:103], v[24:27], v[160:163]
    ds_read_b128 v[140:143], v172 offset:27648
    v_mfma_f32_16x16x32_bf16 v[164:167], v[104:107], v[24:27], v[164:167]
    ds_read_b128 v[144:147], v172 offset:28672
    v_max3_u32 v10, v26, v27, v10
    v_mfma_f32_16x16x32_bf16 v[168:171], v[108:111], v[24:27], v[168:171]
    ds_read_b128 v[148:151], v172 offset:29696
    s_waitcnt lgkmcnt(5) vmcnt(15)
    v_mfma_f32_16x16x32_bf16 v[152:155], v[112:115], v[28:31], v[152:155]
    ds_read_b128 v[92:95], v172 offset:30720
    v_mfma_f32_16x16x32_bf16 v[156:159], v[116:119], v[28:31], v[156:159]
    ds_read_b128 v[96:99], v172 offset:31744
    v_max3_u32 v10, v28, v29, v10
    v_mfma_f32_16x16x32_bf16 v[160:163], v[120:123], v[28:31], v[160:163]
    ds_read_b128 v[100:103], v172 offset:32768
    v_mfma_f32_16x16x32_bf16 v[164:167], v[124:127], v[28:31], v[164:167]
    ds_read_b128 v[104:107], v172 offset:33792
    v_max3_u32 v10, v30, v31, v10
    v_mfma_f32_16x16x32_bf16 v[168:171], v[128:131], v[28:31], v[168:171]
    ds_read_b128 v[108:111], v172 offset:34816
    s_waitcnt lgkmcnt(5) vmcnt(14)
    v_mfma_f32_16x16x32_bf16 v[152:155], v[132:135], v[32:35], v[152:155]
    ds_read_b128 v[112:115], v172 offset:35840
    v_mfma_f32_16x16x32_bf16 v[156:159], v[136:139], v[32:35], v[156:159]
    ds_read_b128 v[116:119], v172 offset:36864
    v_max3_u32 v10, v32, v33, v10
    v_mfma_f32_16x16x32_bf16 v[160:163], v[140:143], v[32:35], v[160:163]
    ds_read_b128 v[120:123], v172 offset:37888
    v_mfma_f32_16x16x32_bf16 v[164:167], v[144:147], v[32:35], v[164:167]
    ds_read_b128 v[124:127], v172 offset:38912
    v_max3_u32 v10, v34, v35, v10
    v_mfma_f32_16x16x32_bf16 v[168:171], v[148:151], v[32:35], v[168:171]
    ds_read_b128 v[128:131], v172 offset:39936
    s_waitcnt lgkmcnt(5) vmcnt(13)
    v_mfma_f32_16x16x32_bf16 v[152:155], v[92:95], v[36:39], v[152:155]
    ds_read_b128 v[132:135], v172 offset:40960
    v_mfma_f32_16x16x32_bf16 v[156:159], v[96:99], v[36:39], v[156:159]
    ds_read_b128 v[136:139], v172 offset:41984
    v_max3_u32 v10, v36, v37, v10
    v_mfma_f32_16x16x32_bf16 v[160:163], v[100:103], v[36:39], v[160:163]
    ds_read_b128 v[140:143], v172 offset:43008
    v_mfma_f32_16x16x32_bf16 v[164:167], v[104:107], v[36:39], v[164:167]
    ds_read_b128 v[144:147], v172 offset:44032
    v_max3_u32 v10, v38, v39, v10
    v_mfma_f32_16x16x32_bf16 v[168:171], v[108:111], v[36:39], v[168:171]
    ds_read_b128 v[148:151], v172 offset:45056
    s_waitcnt lgkmcnt(5) vmcnt(12)
    v_mfma_f32_16x16x32_bf16 v[152:155], v[112:115], v[40:43], v[152:155]
    ds_read_b128 v[92:95], v172 offset:46080
    v_mfma_f32_16x16x32_bf16 v[156:159], v[116:119], v[40:43], v[156:159]
    ds_read_b128 v[96:99], v172 offset:47104
    v_max3_u32 v10, v40, v41, v10
    v_mfma_f32_16x16x32_bf16 v[160:163], v[120:123], v[40:43], v[160:163]
    ds_read_b128 v[100:103], v172 offset:48128
    v_mfma_f32_16x16x32_bf16 v[164:167], v[124:127], v[40:43], v[164:167]
    ds_read_b128 v[104:107], v172 offset:49152
    v_max3_u32 v10, v42, v43, v10
    v_mfma_f32_16x16x32_bf16 v[168:171], v[128:131], v[40:43], v[168:171]
    ds_read_b128 v[108:111], v172 offset:50176
    s_waitcnt lgkmcnt(5) vmcnt(11)
    v_mfma_f32_16x16x32_bf16 v[152:155], v[132:135], v[44:47], v[152:155]
    ds_read_b128 v[112:115], v173 offset:0
    v_mfma_f32_16x16x32_bf16 v[156:159], v[136:139], v[44:47], v[156:159]
    ds_read_b128 v[116:119], v173 offset:1024
    v_max3_u32 v10, v44, v45, v10
    v_mfma_f32_16x16x32_bf16 v[160:163], v[140:143], v[44:47], v[160:163]
    ds_read_b128 v[120:123], v173 offset:2048
    v_mfma_f32_16x16x32_bf16 v[164:167], v[144:147], v[44:47], v[164:167]
    ds_read_b128 v[124:127], v173 offset:3072
    v_max3_u32 v10, v46, v47, v10
    v_mfma_f32_16x16x32_bf16 v[168:171], v[148:151], v[44:47], v[168:171]
    ds_read_b128 v[128:131], v173 offset:4096
    s_waitcnt lgkmcnt(5) vmcnt(10)
    v_mfma_f32_16x16x32_bf16 v[152:155], v[92:95], v[48:51], v[152:155]
    ds_read_b128 v[132:135], v173 offset:5120
    v_mfma_f32_16x16x32_bf16 v[156:159], v[96:99], v[48:51], v[156:159]
    ds_read_b128 v[136:139], v173 offset:6144
    v_max3_u32 v10, v48, v49, v10
    v_mfma_f32_16x16x32_bf16 v[160:163], v[100:103], v[48:51], v[160:163]
    ds_read_b128 v[140:143], v173 offset:7168
    v_mfma_f32_16x16x32_bf16 v[164:167], v[104:107], v[48:51], v[164:167]
    ds_read_b128 v[144:147], v173 offset:8192
    v_max3_u32 v10, v50, v51, v10
    v_mfma_f32_16x16x32_bf16 v[168:171], v[108:111], v[48:51], v[168:171]
    ds_read_b128 v[148:151], v173 offset:9216
    s_waitcnt lgkmcnt(5) vmcnt(9)
    v_mfma_f32_16x16x32_bf16 v[152:155], v[112:115], v[52:55], v[152:155]
    ds_read_b128 v[92:95], v173 offset:10240
    v_mfma_f32_16x16x32_bf16 v[156:159], v[116:119], v[52:55], v[156:159]
    ds_read_b128 v[96:99], v173 offset:11264
    v_max3_u32 v10, v52, v53, v10
    v_mfma_f32_16x16x32_bf16 v[160:163], v[120:123], v[52:55], v[160:163]
    ds_read_b128 v[100:103], v173 offset:12288
    v_mfma_f32_16x16x32_bf16 v[164:167], v[124:127], v[52:55], v[164:167]
    ds_read_b128 v[104:107], v173 offset:13312
    v_max3_u32 v10, v54, v55, v10
    v_mfma_f32_16x16x32_bf16 v[168:171], v[128:131], v[52:55], v[168:171]
    ds_read_b128 v[108:111], v173 offset:14336
    s_waitcnt lgkmcnt(5) vmcnt(8)
    v_mfma_f32_16x16x32_bf16 v[152:155], v[132:135], v[56:59], v[152:155]
    ds_read_b128 v[112:115], v173 offset:15360
    v_mfma_f32_16x16x32_bf16 v[156:159], v[136:139], v[56:59], v[156:159]
    ds_read_b128 v[116:119], v173 offset:16384
    v_max3_u32 v10, v56, v57, v10
    v_mfma_f32_16x16x32_bf16 v[160:163], v[140:143], v[56:59], v[160:163]
    ds_read_b128 v[120:123], v173 offset:17408
    v_mfma_f32_16x16x32_bf16 v[164:167], v[144:147], v[56:59], v[164:167]
    ds_read_b128 v[124:127], v173 offset:18432
    v_max3_u32 v10, v58, v59, v10
    v_mfma_f32_16x16x32_bf16 v[168:171], v[148:151], v[56:59], v[168:171]
    ds_read_b128 v[128:131], v173 offset:19456
    s_waitcnt lgkmcnt(5) vmcnt(7)
    v_mfma_f32_16x16x32_bf16 v[152:155], v[92:95], v[60:63], v[152:155]
    ds_read_b128 v[132:135], v173 offset:20480
    v_mfma_f32_16x16x32_bf16 v[156:159], v[96:99], v[60:63], v[156:159]
    ds_read_b128 v[136:139], v173 offset:21504
    v_max3_u32 v10, v60, v61, v10
    v_mfma_f32_16x16x32_bf16 v[160:163], v[100:103], v[60:63], v[160:163]
    ds_read_b128 v[140:143], v173 offset:22528
    v_mfma_f32_16x16x32_bf16 v[164:167], v[104:107], v[60:63], v[164:167]
    ds_read_b128 v[144:147], v173 offset:23552
    v_max3_u32 v10, v62, v63, v10
    v_mfma_f32_16x16x32_bf16 v[168:171], v[108:111], v[60:63], v[168:171]
    ds_read_b128 v[148:151], v175 offset:0
    s_waitcnt lgkmcnt(5) vmcnt(6)
    v_mfma_f32_16x16x32_bf16 v[152:155], v[112:115], v[64:67], v[152:155]
    ds_read_b128 v[92:95], v175 offset:1024
    v_mfma_f32_16x16x32_bf16 v[156:159], v[116:119], v[64:67], v[156:159]
    ds_read_b128 v[96:99], v175 offset:2048
    v_max3_u32 v10, v64, v65, v10
    v_mfma_f32_16x16x32_bf16 v[160:163], v[120:123], v[64:67], v[160:163]
    ds_read_b128 v[100:103], v175 offset:3072
    v_mfma_f32_16x16x32_bf16 v[164:167], v[124:127], v[64:67], v[164:167]
    ds_read_b128 v[104:107], v175 offset:4096
    v_max3_u32 v10, v66, v67, v10
    v_mfma_f32_16x16x32_bf16 v[168:171], v[128:131], v[64:67], v[168:171]
    ds_read_b128 v[108:111], v175 offset:5120
    s_waitcnt lgkmcnt(5) vmcnt(5)
    v_mfma_f32_16x16x32_bf16 v[152:155], v[132:135], v[68:71], v[152:155]
    ds_read_b128 v[112:115], v175 offset:6144
    v_mfma_f32_16x16x32_bf16 v[156:159], v[136:139], v[68:71], v[156:159]
    ds_read_b128 v[116:119], v175 offset:7168
    v_max3_u32 v10, v68, v69, v10
    v_mfma_f32_16x16x32_bf16 v[160:163], v[140:143], v[68:71], v[160:163]
    ds_read_b128 v[120:123], v175 offset:8192
    v_mfma_f32_16x16x32_bf16 v[164:167], v[144:147], v[68:71], v[164:167]
    ds_read_b128 v[124:127], v175 offset:9216
    v_max3_u32 v10, v70, v71, v10
    v_mfma_f32_16x16x32_bf16 v[168:171], v[148:151], v[68:71], v[168:171]
    ds_read_b128 v[128:131], v175 offset:10240
    s_waitcnt lgkmcnt(5) vmcnt(4)
    v_mfma_f32_16x16x32_bf16 v[152:155], v[92:95], v[72:75], v[152:155]
    ds_read_b128 v[132:135], v175 offset:11264
    v_mfma_f32_16x16x32_bf16 v[156:159], v[96:99], v[72:75], v[156:159]
    ds_read_b128 v[136:139], v175 offset:12288
    v_max3_u32 v10, v72, v73, v10
    v_mfma_f32_16x16x32_bf16 v[160:163], v[100:103], v[72:75], v[160:163]
    ds_read_b128 v[140:143], v175 offset:13312
    v_mfma_f32_16x16x32_bf16 v[164:167], v[104:107], v[72:75], v[164:167]
    ds_read_b128 v[144:147], v175 offset:14336
    v_max3_u32 v10, v74, v75, v10
    v_mfma_f32_16x16x32_bf16 v[168:171], v[108:111], v[72:75], v[168:171]
    ds_read_b128 v[148:151], v175 offset:15360
    s_waitcnt lgkmcnt(5) vmcnt(3)
    v_mfma_f32_16x16x32_bf16 v[152:155], v[112:115], v[76:79], v[152:155]
    ds_read_b128 v[92:95], v175 offset:16384
    v_mfma_f32_16x16x32_bf16 v[156:159], v[116:119], v[76:79], v[156:159]
    ds_read_b128 v[96:99], v175 offset:17408
    v_max3_u32 v10, v76, v77, v10
    v_mfma_f32_16x16x32_bf16 v[160:163], v[120:123], v[76:79], v[160:163]
    ds_read_b128 v[100:103], v175 offset:18432
    v_mfma_f32_16x16x32_bf16 v[164:167], v[124:127], v[76:79], v[164:167]
    ds_read_b128 v[104:107], v175 offset:19456
    v_max3_u32 v10, v78, v79, v10
    v_mfma_f32_16x16x32_bf16 v[168:171], v[128:131], v[76:79], v[168:171]
    ds_read_b128 v[108:111], v175 offset:20480
    s_waitcnt lgkmcnt(5) vmcnt(2)
    v_mfma_f32_16x16x32_bf16 v[152:155], v[132:135], v[80:83], v[152:155]
    ds_read_b128 v[112:115], v175 offset:21504
    v_mfma_f32_16x16x32_bf16 v[156:159], v[136:139], v[80:83], v[156:159]
    ds_read_b128 v[116:119], v175 offset:22528
    v_max3_u32 v10, v80, v81, v10
    v_mfma_f32_16x16x32_bf16 v[160:163], v[140:143], v[80:83], v[160:163]
    ds_read_b128 v[120:123], v175 offset:23552
    v_mfma_f32_16x16x32_bf16 v[164:167], v[144:147], v[80:83], v[164:167]
    ds_read_b128 v[124:127], v175 offset:24576
    v_max3_u32 v10, v82, v83, v10
    v_mfma_f32_16x16x32_bf16 v[168:171], v[148:151], v[80:83], v[168:171]
    ds_read_b128 v[128:131], v175 offset:25600
    s_waitcnt lgkmcnt(5) vmcnt(1)
    v_mfma_f32_16x16x32_bf16 v[152:155], v[92:95], v[84:87], v[152:155]
    v_mfma_f32_16x16x32_bf16 v[156:159], v[96:99], v[84:87], v[156:159]
    v_max3_u32 v10, v84, v85, v10
    v_mfma_f32_16x16x32_bf16 v[160:163], v[100:103], v[84:87], v[160:163]
    v_mfma_f32_16x16x32_bf16 v[164:167], v[104:107], v[84:87], v[164:167]
    v_max3_u32 v10, v86, v87, v10
    v_mfma_f32_16x16x32_bf16 v[168:171], v[108:111], v[84:87], v[168:171]
    s_waitcnt lgkmcnt(0) vmcnt(0)
    v_mfma_f32_16x16x32_bf16 v[152:155], v[112:115], v[88:91], v[152:155]
    v_mfma_f32_16x16x32_bf16 v[156:159], v[116:119], v[88:91], v[156:159]
    v_max3_u32 v10, v88, v89, v10
    v_mfma_f32_16x16x32_bf16 v[160:163], v[120:123], v[88:91], v[160:163]
    v_mfma_f32_16x16x32_bf16 v[164:167], v[124:127], v[88:91], v[164:167]
    v_max3_u32 v10, v90, v91, v10
    v_mfma_f32_16x16x32_bf16 v[168:171], v[128:131], v[88:91], v[168:171]
    v_cmp_eq_u32 vcc, -1, v10
    s_nop 1
    s_cmp_eq_u64 vcc, 0
    s_cbranch_scc0 L_ore_77
L_ook_76:
    s_mul_i32 s26, s25, 160
    s_nop 7
    v_cvt_pk_bf16_f32 v92, v152, v153
    v_cvt_pk_bf16_f32 v93, v154, v155
    ds_write_b64 v179, v[92:93] offset:0
    v_cvt_pk_bf16_f32 v94, v156, v157
    v_cvt_pk_bf16_f32 v95, v158, v159
    ds_write_b64 v179, v[94:95] offset:32
    v_cvt_pk_bf16_f32 v96, v160, v161
    v_cvt_pk_bf16_f32 v97, v162, v163
    ds_write_b64 v179, v[96:97] offset:64
    v_cvt_pk_bf16_f32 v98, v164, v165
    v_cvt_pk_bf16_f32 v99, v166, v167
    ds_write_b64 v179, v[98:99] offset:96
    v_cvt_pk_bf16_f32 v100, v168, v169
    v_cvt_pk_bf16_f32 v101, v170, v171
    ds_write_b64 v179, v[100:101] offset:128
    ds_read_b128 v[112:115], v180 offset:0
    ds_read_b128 v[116:119], v180 offset:1024
    ds_read_b128 v[120:123], v180 offset:2048
    s_waitcnt lgkmcnt(2)
    buffer_store_dwordx4 v[112:115], v176, s[16:19], s26 offen
    s_waitcnt lgkmcnt(1)
    buffer_store_dwordx4 v[116:119], v177, s[16:19], s26 offen
    s_waitcnt lgkmcnt(0)
    s_mov_b64 exec, 0xffffffff
    buffer_store_dwordx4 v[120:123], v178, s[16:19], s26 offen
    s_mov_b64 exec, -1
L_p3_end:
L_exit:
    s_endpgm
L_p1_compute:
    v_lshrrev_b32 v11, 2, v1
    v_and_b32 v9, 3, v1
    s_add_u32 s34, s8, 0
    s_min_u32 s36, s34, 9
    s_and_b32 s45, s36, 1
    s_lshl_b32 s45, s45, 2
    s_lshr_b32 s36, s36, 1
    s_cmp_lt_u32 s34, 10
    s_cselect_b32 s35, 0, 0x7ff00000
    s_lshl_b32 s36, s36, 4
    s_mul_i32 s34, s44, 80
    s_add_u32 s34, s34, s36
    v_add_u32 v4, s34, v11
    v_lshlrev_b32 v140, 12, v4
    v_add_u32 v5, s45, v9
    v_lshlrev_b32 v5, 4, v5
    v_sub_u32 v140, v140, v5
    s_lshl_b32 s36, s43, 7
    s_sub_u32 s36, 12586992, s36
    s_add_u32 s36, s36, s35
    v_add_u32 v140, s36, v140
    s_add_u32 s34, s8, 4
    s_min_u32 s36, s34, 9
    s_and_b32 s45, s36, 1
    s_lshl_b32 s45, s45, 2
    s_lshr_b32 s36, s36, 1
    s_cmp_lt_u32 s34, 10
    s_cselect_b32 s35, 0, 0x7ff00000
    s_lshl_b32 s36, s36, 4
    s_mul_i32 s34, s44, 80
    s_add_u32 s34, s34, s36
    v_add_u32 v4, s34, v11
    v_lshlrev_b32 v141, 12, v4
    v_add_u32 v5, s45, v9
    v_lshlrev_b32 v5, 4, v5
    v_sub_u32 v141, v141, v5
    s_lshl_b32 s36, s43, 7
    s_sub_u32 s36, 12586992, s36
    s_add_u32 s36, s36, s35
    v_add_u32 v141, s36, v141
    s_add_u32 s34, s8, 8
    s_min_u32 s36, s34, 9
    s_and_b32 s45, s36, 1
    s_lshl_b32 s45, s45, 2
    s_lshr_b32 s36, s36, 1
    s_cmp_lt_u32 s34, 10
    s_cselect_b32 s35, 0, 0x7ff00000
    s_lshl_b32 s36, s36, 4
    s_mul_i32 s34, s44, 80
    s_add_u32 s34, s34, s36
    v_add_u32 v4, s34, v11
    v_lshlrev_b32 v142, 12, v4
    v_add_u32 v5, s45, v9
    v_lshlrev_b32 v5, 4, v5
    v_sub_u32 v142, v142, v5
    s_lshl_b32 s36, s43, 7
    s_sub_u32 s36, 12586992, s36
    s_add_u32 s36, s36, s35
    v_add_u32 v142, s36, v142
    s_lshl_b32 s34, s8, 10
    s_add_u32 s34, s34, 153600
    v_lshlrev_b32 v143, 4, v1
    v_add_u32 v143, s34, v143
    s_mov_b32 s12, s64
    s_and_b32 s13, s65, 0xffff
    s_mov_b32 s14, 2621440
    s_mov_b32 s15, 0x20000
    s_mov_b32 s16, s66
    s_and_b32 s17, s67, 0xffff
    s_mov_b32 s18, 2457600
    s_mov_b32 s19, 0x20000
    v_lshlrev_b32 v4, 4, v1
    s_lshr_b32 s35, s2, 3
    s_cmp_ge_u32 s8, 2
    s_cbranch_scc1 L_pfw_2
    s_and_b32 s34, s2, 7
    s_lshl_b32 s34, s34, 5
    s_add_u32 s34, s34, s35
    s_mul_i32 s34, s34, 10240
    s_mul_i32 s35, s8, 5120
    s_add_u32 s34, s34, s35
    buffer_load_dwordx4 v[156:159], v4, s[12:15], s34 offen
    s_add_u32 s34, s34, 1024
    buffer_load_dwordx4 v[156:159], v4, s[12:15], s34 offen
    s_add_u32 s34, s34, 1024
    buffer_load_dwordx4 v[156:159], v4, s[12:15], s34 offen
    s_add_u32 s34, s34, 1024
    buffer_load_dwordx4 v[156:159], v4, s[12:15], s34 offen
    s_add_u32 s34, s34, 1024
    buffer_load_dwordx4 v[156:159], v4, s[12:15], s34 offen
    s_add_u32 s34, s34, 1024
    s_branch L_pfe_3
L_pfw_2:
    s_bfe_u32 s34, s2, 0x20001
    s_lshl_b32 s34, s34, 5
    s_add_u32 s34, s34, s35
    s_mul_i32 s34, s34, 19200
    s_and_b32 s35, s2, 1
    s_lshl_b32 s35, s35, 11
    s_add_u32 s34, s34, s35
    s_and_b32 s35, s8, 1
    s_lshl_b32 s35, s35, 10
    s_add_u32 s34, s34, s35
    buffer_load_dwordx4 v[156:159], v4, s[16:19], s34 offen
    s_add_u32 s34, s34, 3840
    buffer_load_dwordx4 v[156:159], v4, s[16:19], s34 offen
    s_add_u32 s34, s34, 3840
    buffer_load_dwordx4 v[156:159], v4, s[16:19], s34 offen
    s_add_u32 s34, s34, 3840
    buffer_load_dwordx4 v[156:159], v4, s[16:19], s34 offen
    s_add_u32 s34, s34, 3840
    buffer_load_dwordx4 v[156:159], v4, s[16:19], s34 offen
    s_add_u32 s34, s34, 3840
L_pfe_3:
    s_and_b32 s34, s8, 1
    s_lshl_b32 s34, s34, 13
    v_bfe_u32 v4, v1, 2, 3
    v_lshlrev_b32 v5, 10, v4
    v_add_u32 v5, s34, v5
    v_and_b32 v4, 3, v4
    v_and_b32 v6, 3, v1
    v_xor_b32 v4, v4, v6
    v_lshl_add_u32 v5, v4, 6, v5
    v_lshrrev_b32 v7, 5, v1
    v_xor_b32 v7, v7, v6
    v_lshl_add_u32 v12, v7, 4, v5
    v_xor_b32 v13, 32, v12
    v_bfe_u32 v4, v1, 2, 2
    v_lshrrev_b32 v5, 5, v1
    v_lshlrev_b32 v5, 3, v5
    v_add_u32 v5, v5, v4
    v_lshlrev_b32 v5, 8, v5
    v_add_u32 v5, 16384, v5
    v_lshlrev_b32 v4, 6, v4
    v_bfe_u32 v6, v1, 4, 1
    v_lshlrev_b32 v6, 2, v6
    v_and_b32 v7, 3, v1
    v_add_u32 v6, v6, v7
    s_lshr_b32 s34, s8, 1
    s_lshl_b32 s34, s34, 4
    v_add_u32 v6, s34, v6
    v_add_u32 v7, 0, v6
    v_lshlrev_b32 v7, 3, v7
    v_xor_b32 v7, v7, v4
    v_add_u32 v14, v7, v5
    v_add_u32 v7, 8, v6
    v_lshlrev_b32 v7, 3, v7
    v_xor_b32 v7, v7, v4
    v_add_u32 v15, v7, v5
    v_mov_b32 v64, 0
    v_mov_b32 v65, 0
    v_mov_b32 v66, 0
    v_mov_b32 v67, 0
    v_mov_b32 v68, 0
    v_mov_b32 v69, 0
    v_mov_b32 v70, 0
    v_mov_b32 v71, 0
    v_mov_b32 v72, 0
    v_mov_b32 v73, 0
    v_mov_b32 v74, 0
    v_mov_b32 v75, 0
    v_mov_b32 v76, 0
    v_mov_b32 v77, 0
    v_mov_b32 v78, 0
    v_mov_b32 v79, 0
    v_mov_b32 v80, 0
    v_mov_b32 v81, 0
    v_mov_b32 v82, 0
    v_mov_b32 v83, 0
    v_mov_b32 v84, 0
    v_mov_b32 v85, 0
    v_mov_b32 v86, 0
    v_mov_b32 v87, 0
    v_mov_b32 v88, 0
    v_mov_b32 v89, 0
    v_mov_b32 v90, 0
    v_mov_b32 v91, 0
    v_mov_b32 v92, 0
    v_mov_b32 v93, 0
    v_mov_b32 v94, 0
    v_mov_b32 v95, 0
    v_mov_b32 v96, 0
    v_mov_b32 v97, 0
    v_mov_b32 v98, 0
    v_mov_b32 v99, 0
    v_mov_b32 v100, 0
    v_mov_b32 v101, 0
    v_mov_b32 v102, 0
    v_mov_b32 v103, 0
    v_mov_b32 v104, 0
    v_mov_b32 v105, 0
    v_mov_b32 v106, 0
    v_mov_b32 v107, 0
    v_mov_b32 v108, 0
    v_mov_b32 v109, 0
    v_mov_b32 v110, 0
    v_mov_b32 v111, 0
    v_mov_b32 v112, 0
    v_mov_b32 v113, 0
    v_mov_b32 v114, 0
    v_mov_b32 v115, 0
    v_mov_b32 v116, 0
    v_mov_b32 v117, 0
    v_mov_b32 v118, 0
    v_mov_b32 v119, 0
    v_mov_b32 v120, 0
    v_mov_b32 v121, 0
    v_mov_b32 v122, 0
    v_mov_b32 v123, 0
    v_mov_b32 v124, 0
    v_mov_b32 v125, 0
    v_mov_b32 v126, 0
    v_mov_b32 v127, 0
    s_waitcnt vmcnt(5)
    s_barrier
    ds_read_b64_tr_b16 v[166:167], v136 offset:0
    ds_read_b64_tr_b16 v[168:169], v136 offset:640
    ds_read_b64_tr_b16 v[170:171], v136 offset:1280
    ds_read_b64_tr_b16 v[172:173], v136 offset:11904
    ds_read_b64_tr_b16 v[174:175], v136 offset:12544
    v_lshlrev_b32 v196, 16, v132
    v_and_b32 v197, 0xffff0000, v132
    v_lshlrev_b32 v198, 16, v133
    v_and_b32 v199, 0xffff0000, v133
    s_waitcnt lgkmcnt(2)
    v_and_b32 v177, 0xffff0000, v166
    v_lshlrev_b32 v178, 16, v167
    v_and_b32 v179, 0xffff0000, v167
    v_lshlrev_b32 v180, 16, v168
    v_and_b32 v181, 0xffff0000, v168
    v_lshlrev_b32 v182, 16, v169
    v_and_b32 v183, 0xffff0000, v169
    v_lshlrev_b32 v184, 16, v170
    v_and_b32 v185, 0xffff0000, v170
    v_lshlrev_b32 v186, 16, v171
    v_and_b32 v187, 0xffff0000, v171
    v_mul_f32 v200, v199, v177
    v_mul_f32 v201, v199, v178
    v_mul_f32 v202, v199, v179
    v_mul_f32 v203, v199, v180
    v_mul_f32 v204, v199, v181
    v_mul_f32 v205, v199, v182
    v_mul_f32 v206, v199, v183
    v_mul_f32 v207, v199, v184
    v_fmac_f32 v200, v198, v178
    v_fmac_f32 v201, v198, v179
    v_fmac_f32 v202, v198, v180
    v_fmac_f32 v203, v198, v181
    v_fmac_f32 v204, v198, v182
    v_fmac_f32 v205, v198, v183
    v_fmac_f32 v206, v198, v184
    v_fmac_f32 v207, v198, v185
    s_waitcnt lgkmcnt(0)
    v_lshlrev_b32 v188, 16, v172
    v_and_b32 v189, 0xffff0000, v172
    v_lshlrev_b32 v190, 16, v173
    v_and_b32 v191, 0xffff0000, v173
    v_lshlrev_b32 v192, 16, v174
    v_and_b32 v193, 0xffff0000, v174
    v_lshlrev_b32 v194, 16, v175
    v_and_b32 v195, 0xffff0000, v175
    v_fmac_f32 v200, v197, v179
    v_fmac_f32 v201, v197, v180
    v_fmac_f32 v202, v197, v181
    v_fmac_f32 v203, v197, v182
    v_fmac_f32 v204, v197, v183
    v_fmac_f32 v205, v197, v184
    v_fmac_f32 v206, v197, v185
    v_fmac_f32 v207, v197, v186
    v_fmac_f32 v200, v196, v180
    v_fmac_f32 v201, v196, v181
    v_fmac_f32 v202, v196, v182
    v_fmac_f32 v203, v196, v183
    v_fmac_f32 v204, v196, v184
    v_fmac_f32 v205, v196, v185
    v_fmac_f32 v206, v196, v186
    v_fmac_f32 v207, v196, v187
    v_mul_f32 v200, v200, v188
    v_mul_f32 v201, v201, v189
    v_mul_f32 v202, v202, v190
    v_mul_f32 v203, v203, v191
    v_mul_f32 v204, v204, v192
    v_mul_f32 v205, v205, v193
    v_mul_f32 v206, v206, v194
    v_mul_f32 v207, v207, v195
    v_cvt_pk_bf16_f32 v208, v207, v206
    v_cvt_pk_bf16_f32 v209, v205, v204
    v_cvt_pk_bf16_f32 v210, v203, v202
    v_cvt_pk_bf16_f32 v211, v201, v200
    ds_write_b128 v138, v[208:211]
    s_cmp_ge_u32 s8, 2
    s_cbranch_scc1 L_one_4
    ds_read_b64_tr_b16 v[166:167], v137 offset:0
    ds_read_b64_tr_b16 v[168:169], v137 offset:640
    ds_read_b64_tr_b16 v[170:171], v137 offset:1280
    ds_read_b64_tr_b16 v[172:173], v137 offset:11904
    ds_read_b64_tr_b16 v[174:175], v137 offset:12544
    v_lshlrev_b32 v196, 16, v134
    v_and_b32 v197, 0xffff0000, v134
    v_lshlrev_b32 v198, 16, v135
    v_and_b32 v199, 0xffff0000, v135
    s_waitcnt lgkmcnt(2)
    v_and_b32 v177, 0xffff0000, v166
    v_lshlrev_b32 v178, 16, v167
    v_and_b32 v179, 0xffff0000, v167
    v_lshlrev_b32 v180, 16, v168
    v_and_b32 v181, 0xffff0000, v168
    v_lshlrev_b32 v182, 16, v169
    v_and_b32 v183, 0xffff0000, v169
    v_lshlrev_b32 v184, 16, v170
    v_and_b32 v185, 0xffff0000, v170
    v_lshlrev_b32 v186, 16, v171
    v_and_b32 v187, 0xffff0000, v171
    v_mul_f32 v200, v199, v177
    v_mul_f32 v201, v199, v178
    v_mul_f32 v202, v199, v179
    v_mul_f32 v203, v199, v180
    v_mul_f32 v204, v199, v181
    v_mul_f32 v205, v199, v182
    v_mul_f32 v206, v199, v183
    v_mul_f32 v207, v199, v184
    v_fmac_f32 v200, v198, v178
    v_fmac_f32 v201, v198, v179
    v_fmac_f32 v202, v198, v180
    v_fmac_f32 v203, v198, v181
    v_fmac_f32 v204, v198, v182
    v_fmac_f32 v205, v198, v183
    v_fmac_f32 v206, v198, v184
    v_fmac_f32 v207, v198, v185
    s_waitcnt lgkmcnt(0)
    v_lshlrev_b32 v188, 16, v172
    v_and_b32 v189, 0xffff0000, v172
    v_lshlrev_b32 v190, 16, v173
    v_and_b32 v191, 0xffff0000, v173
    v_lshlrev_b32 v192, 16, v174
    v_and_b32 v193, 0xffff0000, v174
    v_lshlrev_b32 v194, 16, v175
    v_and_b32 v195, 0xffff0000, v175
    v_fmac_f32 v200, v197, v179
    v_fmac_f32 v201, v197, v180
    v_fmac_f32 v202, v197, v181
    v_fmac_f32 v203, v197, v182
    v_fmac_f32 v204, v197, v183
    v_fmac_f32 v205, v197, v184
    v_fmac_f32 v206, v197, v185
    v_fmac_f32 v207, v197, v186
    v_fmac_f32 v200, v196, v180
    v_fmac_f32 v201, v196, v181
    v_fmac_f32 v202, v196, v182
    v_fmac_f32 v203, v196, v183
    v_fmac_f32 v204, v196, v184
    v_fmac_f32 v205, v196, v185
    v_fmac_f32 v206, v196, v186
    v_fmac_f32 v207, v196, v187
    v_mul_f32 v200, v200, v188
    v_mul_f32 v201, v201, v189
    v_mul_f32 v202, v202, v190
    v_mul_f32 v203, v203, v191
    v_mul_f32 v204, v204, v192
    v_mul_f32 v205, v205, v193
    v_mul_f32 v206, v206, v194
    v_mul_f32 v207, v207, v195
    v_cvt_pk_bf16_f32 v208, v207, v206
    v_cvt_pk_bf16_f32 v209, v205, v204
    v_cvt_pk_bf16_f32 v210, v203, v202
    v_cvt_pk_bf16_f32 v211, v201, v200
    ds_write_b128 v139, v[208:211]
L_one_4:
    s_waitcnt lgkmcnt(0)
    s_barrier
    ds_read_b128 v[144:147], v143 offset:0
    ds_read_b128 v[148:151], v143 offset:4096
    ds_read_b128 v[152:155], v143 offset:8192
    s_cmp_ge_u32 s32, 15
    s_cbranch_scc1 L_p1_idle
    s_waitcnt lgkmcnt(0)
    buffer_store_dwordx4 v[144:147], v140, s[4:7], 0 offen sc1
    buffer_store_dwordx4 v[148:151], v141, s[4:7], 0 offen sc1
    buffer_store_dwordx4 v[152:155], v142, s[4:7], 0 offen sc1
    ds_read_b128 v[16:19], v12 offset:0
    ds_read_b64_tr_b16 v[24:25], v14 offset:0
    ds_read_b64_tr_b16 v[26:27], v14 offset:1024
    ds_read_b128 v[20:23], v12 offset:512
    ds_read_b64_tr_b16 v[28:29], v15 offset:0
    ds_read_b64_tr_b16 v[30:31], v15 offset:1024
    ds_read_b128 v[32:35], v13 offset:0
    ds_read_b64_tr_b16 v[40:41], v14 offset:4096
    ds_read_b64_tr_b16 v[42:43], v14 offset:5120
    ds_read_b128 v[36:39], v13 offset:512
    ds_read_b64_tr_b16 v[44:45], v15 offset:4096
    ds_read_b64_tr_b16 v[46:47], v15 offset:5120
    s_waitcnt lgkmcnt(6)
    v_mfma_f32_32x32x16_bf16 v[64:79], v[24:27], v[16:19], v[64:79]
    ds_read_b128 v[48:51], v12 offset:256
    ds_read_b64_tr_b16 v[56:57], v14 offset:8192
    ds_read_b64_tr_b16 v[58:59], v14 offset:9216
    v_mfma_f32_32x32x16_bf16 v[80:95], v[24:27], v[20:23], v[80:95]
    ds_read_b128 v[52:55], v12 offset:768
    ds_read_b64_tr_b16 v[60:61], v15 offset:8192
    ds_read_b64_tr_b16 v[62:63], v15 offset:9216
    v_mfma_f32_32x32x16_bf16 v[96:111], v[28:31], v[16:19], v[96:111]
    v_mfma_f32_32x32x16_bf16 v[112:127], v[28:31], v[20:23], v[112:127]
    s_waitcnt lgkmcnt(6)
    v_mfma_f32_32x32x16_bf16 v[64:79], v[40:43], v[32:35], v[64:79]
    ds_read_b128 v[16:19], v13 offset:256
    ds_read_b64_tr_b16 v[24:25], v14 offset:12288
    ds_read_b64_tr_b16 v[26:27], v14 offset:13312
    v_mfma_f32_32x32x16_bf16 v[80:95], v[40:43], v[36:39], v[80:95]
    ds_read_b128 v[20:23], v13 offset:768
    ds_read_b64_tr_b16 v[28:29], v15 offset:12288
    ds_read_b64_tr_b16 v[30:31], v15 offset:13312
    v_mfma_f32_32x32x16_bf16 v[96:111], v[44:47], v[32:35], v[96:111]
    v_mfma_f32_32x32x16_bf16 v[112:127], v[44:47], v[36:39], v[112:127]
    s_waitcnt lgkmcnt(0)
    s_barrier
    v_mfma_f32_32x32x16_bf16 v[64:79], v[56:59], v[48:51], v[64:79]
    ds_read_b128 v[32:35], v12 offset:32768
    ds_read_b64_tr_b16 v[40:41], v14 offset:32768
    ds_read_b64_tr_b16 v[42:43], v14 offset:33792
    v_mfma_f32_32x32x16_bf16 v[80:95], v[56:59], v[52:55], v[80:95]
    ds_read_b128 v[36:39], v12 offset:33280
    ds_read_b64_tr_b16 v[44:45], v15 offset:32768
    ds_read_b64_tr_b16 v[46:47], v15 offset:33792
    v_mfma_f32_32x32x16_bf16 v[96:111], v[60:63], v[48:51], v[96:111]
    v_mfma_f32_32x32x16_bf16 v[112:127], v[60:63], v[52:55], v[112:127]
    v_mfma_f32_32x32x16_bf16 v[64:79], v[24:27], v[16:19], v[64:79]
    ds_read_b128 v[48:51], v13 offset:32768
    ds_read_b64_tr_b16 v[56:57], v14 offset:36864
    ds_read_b64_tr_b16 v[58:59], v14 offset:37888
    v_mfma_f32_32x32x16_bf16 v[80:95], v[24:27], v[20:23], v[80:95]
    ds_read_b128 v[52:55], v13 offset:33280
    ds_read_b64_tr_b16 v[60:61], v15 offset:36864
    ds_read_b64_tr_b16 v[62:63], v15 offset:37888
    v_mfma_f32_32x32x16_bf16 v[96:111], v[28:31], v[16:19], v[96:111]
    v_mfma_f32_32x32x16_bf16 v[112:127], v[28:31], v[20:23], v[112:127]
    s_waitcnt lgkmcnt(6)
    v_mfma_f32_32x32x16_bf16 v[64:79], v[40:43], v[32:35], v[64:79]
    ds_read_b128 v[16:19], v12 offset:33024
    ds_read_b64_tr_b16 v[24:25], v14 offset:40960
    ds_read_b64_tr_b16 v[26:27], v14 offset:41984
    v_mfma_f32_32x32x16_bf16 v[80:95], v[40:43], v[36:39], v[80:95]
    ds_read_b128 v[20:23], v12 offset:33536
    ds_read_b64_tr_b16 v[28:29], v15 offset:40960
    ds_read_b64_tr_b16 v[30:31], v15 offset:41984
    v_mfma_f32_32x32x16_bf16 v[96:111], v[44:47], v[32:35], v[96:111]
    v_mfma_f32_32x32x16_bf16 v[112:127], v[44:47], v[36:39], v[112:127]
    s_waitcnt lgkmcnt(6)
    v_mfma_f32_32x32x16_bf16 v[64:79], v[56:59], v[48:51], v[64:79]
    ds_read_b128 v[32:35], v13 offset:33024
    ds_read_b64_tr_b16 v[40:41], v14 offset:45056
    ds_read_b64_tr_b16 v[42:43], v14 offset:46080
    v_mfma_f32_32x32x16_bf16 v[80:95], v[56:59], v[52:55], v[80:95]
    ds_read_b128 v[36:39], v13 offset:33536
    ds_read_b64_tr_b16 v[44:45], v15 offset:45056
    ds_read_b64_tr_b16 v[46:47], v15 offset:46080
    v_mfma_f32_32x32x16_bf16 v[96:111], v[60:63], v[48:51], v[96:111]
    v_mfma_f32_32x32x16_bf16 v[112:127], v[60:63], v[52:55], v[112:127]
    s_waitcnt lgkmcnt(0)
    s_waitcnt vmcnt(0)
    v_xor_b32 v12, 65536, v12
    v_xor_b32 v13, 65536, v13
    v_xor_b32 v14, 65536, v14
    v_xor_b32 v15, 65536, v15
    s_barrier
    v_mfma_f32_32x32x16_bf16 v[64:79], v[24:27], v[16:19], v[64:79]
    ds_read_b128 v[48:51], v12 offset:0
    ds_read_b64_tr_b16 v[56:57], v14 offset:0
    ds_read_b64_tr_b16 v[58:59], v14 offset:1024
    v_mfma_f32_32x32x16_bf16 v[80:95], v[24:27], v[20:23], v[80:95]
    ds_read_b128 v[52:55], v12 offset:512
    ds_read_b64_tr_b16 v[60:61], v15 offset:0
    ds_read_b64_tr_b16 v[62:63], v15 offset:1024
    v_mfma_f32_32x32x16_bf16 v[96:111], v[28:31], v[16:19], v[96:111]
    v_mfma_f32_32x32x16_bf16 v[112:127], v[28:31], v[20:23], v[112:127]
    v_mfma_f32_32x32x16_bf16 v[64:79], v[40:43], v[32:35], v[64:79]
    ds_read_b128 v[16:19], v13 offset:0
    ds_read_b64_tr_b16 v[24:25], v14 offset:4096
    ds_read_b64_tr_b16 v[26:27], v14 offset:5120
    v_mfma_f32_32x32x16_bf16 v[80:95], v[40:43], v[36:39], v[80:95]
    ds_read_b128 v[20:23], v13 offset:512
    ds_read_b64_tr_b16 v[28:29], v15 offset:4096
    ds_read_b64_tr_b16 v[30:31], v15 offset:5120
    v_mfma_f32_32x32x16_bf16 v[96:111], v[44:47], v[32:35], v[96:111]
    v_mfma_f32_32x32x16_bf16 v[112:127], v[44:47], v[36:39], v[112:127]
    s_waitcnt lgkmcnt(6)
    v_mfma_f32_32x32x16_bf16 v[64:79], v[56:59], v[48:51], v[64:79]
    ds_read_b128 v[32:35], v12 offset:256
    ds_read_b64_tr_b16 v[40:41], v14 offset:8192
    ds_read_b64_tr_b16 v[42:43], v14 offset:9216
    v_mfma_f32_32x32x16_bf16 v[80:95], v[56:59], v[52:55], v[80:95]
    ds_read_b128 v[36:39], v12 offset:768
    ds_read_b64_tr_b16 v[44:45], v15 offset:8192
    ds_read_b64_tr_b16 v[46:47], v15 offset:9216
    v_mfma_f32_32x32x16_bf16 v[96:111], v[60:63], v[48:51], v[96:111]
    v_mfma_f32_32x32x16_bf16 v[112:127], v[60:63], v[52:55], v[112:127]
    s_waitcnt lgkmcnt(6)
    v_mfma_f32_32x32x16_bf16 v[64:79], v[24:27], v[16:19], v[64:79]
    ds_read_b128 v[48:51], v13 offset:256
    ds_read_b64_tr_b16 v[56:57], v14 offset:12288
    ds_read_b64_tr_b16 v[58:59], v14 offset:13312
    v_mfma_f32_32x32x16_bf16 v[80:95], v[24:27], v[20:23], v[80:95]
    ds_read_b128 v[52:55], v13 offset:768
    ds_read_b64_tr_b16 v[60:61], v15 offset:12288
    ds_read_b64_tr_b16 v[62:63], v15 offset:13312
    v_mfma_f32_32x32x16_bf16 v[96:111], v[28:31], v[16:19], v[96:111]
    v_mfma_f32_32x32x16_bf16 v[112:127], v[28:31], v[20:23], v[112:127]
    s_waitcnt lgkmcnt(0)
    s_barrier
    v_mfma_f32_32x32x16_bf16 v[64:79], v[40:43], v[32:35], v[64:79]
    ds_read_b128 v[16:19], v12 offset:32768
    ds_read_b64_tr_b16 v[24:25], v14 offset:32768
    ds_read_b64_tr_b16 v[26:27], v14 offset:33792
    v_mfma_f32_32x32x16_bf16 v[80:95], v[40:43], v[36:39], v[80:95]
    ds_read_b128 v[20:23], v12 offset:33280
    ds_read_b64_tr_b16 v[28:29], v15 offset:32768
    ds_read_b64_tr_b16 v[30:31], v15 offset:33792
    v_mfma_f32_32x32x16_bf16 v[96:111], v[44:47], v[32:35], v[96:111]
    v_mfma_f32_32x32x16_bf16 v[112:127], v[44:47], v[36:39], v[112:127]
    v_mfma_f32_32x32x16_bf16 v[64:79], v[56:59], v[48:51], v[64:79]
    ds_read_b128 v[32:35], v13 offset:32768
    ds_read_b64_tr_b16 v[40:41], v14 offset:36864
    ds_read_b64_tr_b16 v[42:43], v14 offset:37888
    v_mfma_f32_32x32x16_bf16 v[80:95], v[56:59], v[52:55], v[80:95]
    ds_read_b128 v[36:39], v13 offset:33280
    ds_read_b64_tr_b16 v[44:45], v15 offset:36864
    ds_read_b64_tr_b16 v[46:47], v15 offset:37888
    v_mfma_f32_32x32x16_bf16 v[96:111], v[60:63], v[48:51], v[96:111]
    v_mfma_f32_32x32x16_bf16 v[112:127], v[60:63], v[52:55], v[112:127]
    s_waitcnt lgkmcnt(6)
    v_mfma_f32_32x32x16_bf16 v[64:79], v[24:27], v[16:19], v[64:79]
    ds_read_b128 v[48:51], v12 offset:33024
    ds_read_b64_tr_b16 v[56:57], v14 offset:40960
    ds_read_b64_tr_b16 v[58:59], v14 offset:41984
    v_mfma_f32_32x32x16_bf16 v[80:95], v[24:27], v[20:23], v[80:95]
    ds_read_b128 v[52:55], v12 offset:33536
    ds_read_b64_tr_b16 v[60:61], v15 offset:40960
    ds_read_b64_tr_b16 v[62:63], v15 offset:41984
    v_mfma_f32_32x32x16_bf16 v[96:111], v[28:31], v[16:19], v[96:111]
    v_mfma_f32_32x32x16_bf16 v[112:127], v[28:31], v[20:23], v[112:127]
    s_waitcnt lgkmcnt(6)
    v_mfma_f32_32x32x16_bf16 v[64:79], v[40:43], v[32:35], v[64:79]
    ds_read_b128 v[16:19], v13 offset:33024
    ds_read_b64_tr_b16 v[24:25], v14 offset:45056
    ds_read_b64_tr_b16 v[26:27], v14 offset:46080
    v_mfma_f32_32x32x16_bf16 v[80:95], v[40:43], v[36:39], v[80:95]
    ds_read_b128 v[20:23], v13 offset:33536
    ds_read_b64_tr_b16 v[28:29], v15 offset:45056
    ds_read_b64_tr_b16 v[30:31], v15 offset:46080
    v_mfma_f32_32x32x16_bf16 v[96:111], v[44:47], v[32:35], v[96:111]
    v_mfma_f32_32x32x16_bf16 v[112:127], v[44:47], v[36:39], v[112:127]
    s_waitcnt lgkmcnt(0)
    v_xor_b32 v12, 65536, v12
    v_xor_b32 v13, 65536, v13
    v_xor_b32 v14, 65536, v14
    v_xor_b32 v15, 65536, v15
    s_barrier
    v_mfma_f32_32x32x16_bf16 v[64:79], v[56:59], v[48:51], v[64:79]
    ds_read_b128 v[32:35], v12 offset:0
    ds_read_b64_tr_b16 v[40:41], v14 offset:0
    ds_read_b64_tr_b16 v[42:43], v14 offset:1024
    v_mfma_f32_32x32x16_bf16 v[80:95], v[56:59], v[52:55], v[80:95]
    ds_read_b128 v[36:39], v12 offset:512
    ds_read_b64_tr_b16 v[44:45], v15 offset:0
    ds_read_b64_tr_b16 v[46:47], v15 offset:1024
    v_mfma_f32_32x32x16_bf16 v[96:111], v[60:63], v[48:51], v[96:111]
    v_mfma_f32_32x32x16_bf16 v[112:127], v[60:63], v[52:55], v[112:127]
    v_mfma_f32_32x32x16_bf16 v[64:79], v[24:27], v[16:19], v[64:79]
    ds_read_b128 v[48:51], v13 offset:0
    ds_read_b64_tr_b16 v[56:57], v14 offset:4096
    ds_read_b64_tr_b16 v[58:59], v14 offset:5120
    v_mfma_f32_32x32x16_bf16 v[80:95], v[24:27], v[20:23], v[80:95]
    ds_read_b128 v[52:55], v13 offset:512
    ds_read_b64_tr_b16 v[60:61], v15 offset:4096
    ds_read_b64_tr_b16 v[62:63], v15 offset:5120
    v_mfma_f32_32x32x16_bf16 v[96:111], v[28:31], v[16:19], v[96:111]
    v_mfma_f32_32x32x16_bf16 v[112:127], v[28:31], v[20:23], v[112:127]
    s_waitcnt lgkmcnt(6)
    v_mfma_f32_32x32x16_bf16 v[64:79], v[40:43], v[32:35], v[64:79]
    ds_read_b128 v[16:19], v12 offset:256
    ds_read_b64_tr_b16 v[24:25], v14 offset:8192
    ds_read_b64_tr_b16 v[26:27], v14 offset:9216
    v_mfma_f32_32x32x16_bf16 v[80:95], v[40:43], v[36:39], v[80:95]
    ds_read_b128 v[20:23], v12 offset:768
    ds_read_b64_tr_b16 v[28:29], v15 offset:8192
    ds_read_b64_tr_b16 v[30:31], v15 offset:9216
    v_mfma_f32_32x32x16_bf16 v[96:111], v[44:47], v[32:35], v[96:111]
    v_mfma_f32_32x32x16_bf16 v[112:127], v[44:47], v[36:39], v[112:127]
    s_waitcnt lgkmcnt(6)
    v_mfma_f32_32x32x16_bf16 v[64:79], v[56:59], v[48:51], v[64:79]
    ds_read_b128 v[32:35], v13 offset:256
    ds_read_b64_tr_b16 v[40:41], v14 offset:12288
    ds_read_b64_tr_b16 v[42:43], v14 offset:13312
    v_mfma_f32_32x32x16_bf16 v[80:95], v[56:59], v[52:55], v[80:95]
    ds_read_b128 v[36:39], v13 offset:768
    ds_read_b64_tr_b16 v[44:45], v15 offset:12288
    ds_read_b64_tr_b16 v[46:47], v15 offset:13312
    v_mfma_f32_32x32x16_bf16 v[96:111], v[60:63], v[48:51], v[96:111]
    v_mfma_f32_32x32x16_bf16 v[112:127], v[60:63], v[52:55], v[112:127]
    s_waitcnt lgkmcnt(0)
    s_barrier
    v_mfma_f32_32x32x16_bf16 v[64:79], v[24:27], v[16:19], v[64:79]
    ds_read_b128 v[48:51], v12 offset:32768
    ds_read_b64_tr_b16 v[56:57], v14 offset:32768
    ds_read_b64_tr_b16 v[58:59], v14 offset:33792
    v_mfma_f32_32x32x16_bf16 v[80:95], v[24:27], v[20:23], v[80:95]
    ds_read_b128 v[52:55], v12 offset:33280
    ds_read_b64_tr_b16 v[60:61], v15 offset:32768
    ds_read_b64_tr_b16 v[62:63], v15 offset:33792
    v_mfma_f32_32x32x16_bf16 v[96:111], v[28:31], v[16:19], v[96:111]
    v_mfma_f32_32x32x16_bf16 v[112:127], v[28:31], v[20:23], v[112:127]
    v_mfma_f32_32x32x16_bf16 v[64:79], v[40:43], v[32:35], v[64:79]
    ds_read_b128 v[16:19], v13 offset:32768
    ds_read_b64_tr_b16 v[24:25], v14 offset:36864
    ds_read_b64_tr_b16 v[26:27], v14 offset:37888
    v_mfma_f32_32x32x16_bf16 v[80:95], v[40:43], v[36:39], v[80:95]
    ds_read_b128 v[20:23], v13 offset:33280
    ds_read_b64_tr_b16 v[28:29], v15 offset:36864
    ds_read_b64_tr_b16 v[30:31], v15 offset:37888
    v_mfma_f32_32x32x16_bf16 v[96:111], v[44:47], v[32:35], v[96:111]
    v_mfma_f32_32x32x16_bf16 v[112:127], v[44:47], v[36:39], v[112:127]
    s_waitcnt lgkmcnt(6)
    v_mfma_f32_32x32x16_bf16 v[64:79], v[56:59], v[48:51], v[64:79]
    ds_read_b128 v[32:35], v12 offset:33024
    ds_read_b64_tr_b16 v[40:41], v14 offset:40960
    ds_read_b64_tr_b16 v[42:43], v14 offset:41984
    v_mfma_f32_32x32x16_bf16 v[80:95], v[56:59], v[52:55], v[80:95]
    ds_read_b128 v[36:39], v12 offset:33536
    ds_read_b64_tr_b16 v[44:45], v15 offset:40960
    ds_read_b64_tr_b16 v[46:47], v15 offset:41984
    v_mfma_f32_32x32x16_bf16 v[96:111], v[60:63], v[48:51], v[96:111]
    v_mfma_f32_32x32x16_bf16 v[112:127], v[60:63], v[52:55], v[112:127]
    s_waitcnt lgkmcnt(6)
    v_mfma_f32_32x32x16_bf16 v[64:79], v[24:27], v[16:19], v[64:79]
    ds_read_b128 v[48:51], v13 offset:33024
    ds_read_b64_tr_b16 v[56:57], v14 offset:45056
    ds_read_b64_tr_b16 v[58:59], v14 offset:46080
    v_mfma_f32_32x32x16_bf16 v[80:95], v[24:27], v[20:23], v[80:95]
    ds_read_b128 v[52:55], v13 offset:33536
    ds_read_b64_tr_b16 v[60:61], v15 offset:45056
    ds_read_b64_tr_b16 v[62:63], v15 offset:46080
    v_mfma_f32_32x32x16_bf16 v[96:111], v[28:31], v[16:19], v[96:111]
    v_mfma_f32_32x32x16_bf16 v[112:127], v[28:31], v[20:23], v[112:127]
    s_waitcnt lgkmcnt(0)
    v_xor_b32 v12, 65536, v12
    v_xor_b32 v13, 65536, v13
    v_xor_b32 v14, 65536, v14
    v_xor_b32 v15, 65536, v15
    s_barrier
    v_mfma_f32_32x32x16_bf16 v[64:79], v[40:43], v[32:35], v[64:79]
    ds_read_b128 v[16:19], v12 offset:0
    ds_read_b64_tr_b16 v[24:25], v14 offset:0
    ds_read_b64_tr_b16 v[26:27], v14 offset:1024
    v_mfma_f32_32x32x16_bf16 v[80:95], v[40:43], v[36:39], v[80:95]
    ds_read_b128 v[20:23], v12 offset:512
    ds_read_b64_tr_b16 v[28:29], v15 offset:0
    ds_read_b64_tr_b16 v[30:31], v15 offset:1024
    v_mfma_f32_32x32x16_bf16 v[96:111], v[44:47], v[32:35], v[96:111]
    v_mfma_f32_32x32x16_bf16 v[112:127], v[44:47], v[36:39], v[112:127]
    v_mfma_f32_32x32x16_bf16 v[64:79], v[56:59], v[48:51], v[64:79]
    ds_read_b128 v[32:35], v13 offset:0
    ds_read_b64_tr_b16 v[40:41], v14 offset:4096
    ds_read_b64_tr_b16 v[42:43], v14 offset:5120
    v_mfma_f32_32x32x16_bf16 v[80:95], v[56:59], v[52:55], v[80:95]
    ds_read_b128 v[36:39], v13 offset:512
    ds_read_b64_tr_b16 v[44:45], v15 offset:4096
    ds_read_b64_tr_b16 v[46:47], v15 offset:5120
    v_mfma_f32_32x32x16_bf16 v[96:111], v[60:63], v[48:51], v[96:111]
    v_mfma_f32_32x32x16_bf16 v[112:127], v[60:63], v[52:55], v[112:127]
    s_waitcnt lgkmcnt(6)
    v_mfma_f32_32x32x16_bf16 v[64:79], v[24:27], v[16:19], v[64:79]
    ds_read_b128 v[48:51], v12 offset:256
    ds_read_b64_tr_b16 v[56:57], v14 offset:8192
    ds_read_b64_tr_b16 v[58:59], v14 offset:9216
    v_mfma_f32_32x32x16_bf16 v[80:95], v[24:27], v[20:23], v[80:95]
    ds_read_b128 v[52:55], v12 offset:768
    ds_read_b64_tr_b16 v[60:61], v15 offset:8192
    ds_read_b64_tr_b16 v[62:63], v15 offset:9216
    v_mfma_f32_32x32x16_bf16 v[96:111], v[28:31], v[16:19], v[96:111]
    v_mfma_f32_32x32x16_bf16 v[112:127], v[28:31], v[20:23], v[112:127]
    s_waitcnt lgkmcnt(6)
    v_mfma_f32_32x32x16_bf16 v[64:79], v[40:43], v[32:35], v[64:79]
    ds_read_b128 v[16:19], v13 offset:256
    ds_read_b64_tr_b16 v[24:25], v14 offset:12288
    ds_read_b64_tr_b16 v[26:27], v14 offset:13312
    v_mfma_f32_32x32x16_bf16 v[80:95], v[40:43], v[36:39], v[80:95]
    ds_read_b128 v[20:23], v13 offset:768
    ds_read_b64_tr_b16 v[28:29], v15 offset:12288
    ds_read_b64_tr_b16 v[30:31], v15 offset:13312
    v_mfma_f32_32x32x16_bf16 v[96:111], v[44:47], v[32:35], v[96:111]
    v_mfma_f32_32x32x16_bf16 v[112:127], v[44:47], v[36:39], v[112:127]
    s_waitcnt lgkmcnt(0)
    s_barrier
    v_mfma_f32_32x32x16_bf16 v[64:79], v[56:59], v[48:51], v[64:79]
    s_cmp_eq_u32 s8, 0
    s_cbranch_scc1 L_nf_5
    v_mov_b32 v160, -1
    v_mov_b32 v161, -1
    v_mov_b32 v162, -1
    v_mov_b32 v163, -1
    v_lshlrev_b32 v164, 4, v1
    s_and_b32 s34, s2, 7
    s_lshl_b32 s34, s34, 2
    s_bfe_u32 s35, s2, 0x20003
    s_add_u32 s34, s34, s35
    s_mul_i32 s34, s34, 81920
    s_lshr_b32 s35, s2, 5
    s_mul_i32 s35, s35, 10240
    s_add_u32 s34, s34, s35
    s_add_u32 s34, s34, 8388608
    s_sub_u32 s35, s8, 1
    s_lshl_b32 s35, s35, 12
    s_min_u32 s35, s35, 6144
    s_add_u32 s34, s34, s35
    buffer_store_dwordx4 v[160:163], v164, s[4:7], s34 offen offset:0 sc1
    buffer_store_dwordx4 v[160:163], v164, s[4:7], s34 offen offset:1024 sc1
    buffer_store_dwordx4 v[160:163], v164, s[4:7], s34 offen offset:2048 sc1
    buffer_store_dwordx4 v[160:163], v164, s[4:7], s34 offen offset:3072 sc1
L_nf_5:
    ds_read_b128 v[32:35], v12 offset:32768
    ds_read_b64_tr_b16 v[40:41], v14 offset:32768
    ds_read_b64_tr_b16 v[42:43], v14 offset:33792
    v_mfma_f32_32x32x16_bf16 v[80:95], v[56:59], v[52:55], v[80:95]
    ds_read_b128 v[36:39], v12 offset:33280
    ds_read_b64_tr_b16 v[44:45], v15 offset:32768
    ds_read_b64_tr_b16 v[46:47], v15 offset:33792
    v_mfma_f32_32x32x16_bf16 v[96:111], v[60:63], v[48:51], v[96:111]
    v_mfma_f32_32x32x16_bf16 v[112:127], v[60:63], v[52:55], v[112:127]
    v_mfma_f32_32x32x16_bf16 v[64:79], v[24:27], v[16:19], v[64:79]
    ds_read_b128 v[48:51], v13 offset:32768
    ds_read_b64_tr_b16 v[56:57], v14 offset:36864
    ds_read_b64_tr_b16 v[58:59], v14 offset:37888
    v_mfma_f32_32x32x16_bf16 v[80:95], v[24:27], v[20:23], v[80:95]
    ds_read_b128 v[52:55], v13 offset:33280
    ds_read_b64_tr_b16 v[60:61], v15 offset:36864
    ds_read_b64_tr_b16 v[62:63], v15 offset:37888
    v_mfma_f32_32x32x16_bf16 v[96:111], v[28:31], v[16:19], v[96:111]
    v_mfma_f32_32x32x16_bf16 v[112:127], v[28:31], v[20:23], v[112:127]
    s_waitcnt lgkmcnt(6)
    v_mfma_f32_32x32x16_bf16 v[64:79], v[40:43], v[32:35], v[64:79]
    ds_read_b128 v[16:19], v12 offset:33024
    ds_read_b64_tr_b16 v[24:25], v14 offset:40960
    ds_read_b64_tr_b16 v[26:27], v14 offset:41984
    v_mfma_f32_32x32x16_bf16 v[80:95], v[40:43], v[36:39], v[80:95]
    ds_read_b128 v[20:23], v12 offset:33536
    ds_read_b64_tr_b16 v[28:29], v15 offset:40960
    ds_read_b64_tr_b16 v[30:31], v15 offset:41984
    v_mfma_f32_32x32x16_bf16 v[96:111], v[44:47], v[32:35], v[96:111]
    v_mfma_f32_32x32x16_bf16 v[112:127], v[44:47], v[36:39], v[112:127]
    s_waitcnt lgkmcnt(6)
    v_mfma_f32_32x32x16_bf16 v[64:79], v[56:59], v[48:51], v[64:79]
    ds_read_b128 v[32:35], v13 offset:33024
    ds_read_b64_tr_b16 v[40:41], v14 offset:45056
    ds_read_b64_tr_b16 v[42:43], v14 offset:46080
    v_mfma_f32_32x32x16_bf16 v[80:95], v[56:59], v[52:55], v[80:95]
    ds_read_b128 v[36:39], v13 offset:33536
    ds_read_b64_tr_b16 v[44:45], v15 offset:45056
    ds_read_b64_tr_b16 v[46:47], v15 offset:46080
    v_mfma_f32_32x32x16_bf16 v[96:111], v[60:63], v[48:51], v[96:111]
    v_mfma_f32_32x32x16_bf16 v[112:127], v[60:63], v[52:55], v[112:127]
    s_waitcnt lgkmcnt(0)
    v_xor_b32 v12, 65536, v12
    v_xor_b32 v13, 65536, v13
    v_xor_b32 v14, 65536, v14
    v_xor_b32 v15, 65536, v15
    s_barrier
    v_mfma_f32_32x32x16_bf16 v[64:79], v[24:27], v[16:19], v[64:79]
    ds_read_b128 v[48:51], v12 offset:0
    ds_read_b64_tr_b16 v[56:57], v14 offset:0
    ds_read_b64_tr_b16 v[58:59], v14 offset:1024
    v_mfma_f32_32x32x16_bf16 v[80:95], v[24:27], v[20:23], v[80:95]
    ds_read_b128 v[52:55], v12 offset:512
    ds_read_b64_tr_b16 v[60:61], v15 offset:0
    ds_read_b64_tr_b16 v[62:63], v15 offset:1024
    v_mfma_f32_32x32x16_bf16 v[96:111], v[28:31], v[16:19], v[96:111]
    v_mfma_f32_32x32x16_bf16 v[112:127], v[28:31], v[20:23], v[112:127]
    v_mfma_f32_32x32x16_bf16 v[64:79], v[40:43], v[32:35], v[64:79]
    ds_read_b128 v[16:19], v13 offset:0
    ds_read_b64_tr_b16 v[24:25], v14 offset:4096
    ds_read_b64_tr_b16 v[26:27], v14 offset:5120
    v_mfma_f32_32x32x16_bf16 v[80:95], v[40:43], v[36:39], v[80:95]
    ds_read_b128 v[20:23], v13 offset:512
    ds_read_b64_tr_b16 v[28:29], v15 offset:4096
    ds_read_b64_tr_b16 v[30:31], v15 offset:5120
    v_mfma_f32_32x32x16_bf16 v[96:111], v[44:47], v[32:35], v[96:111]
    v_mfma_f32_32x32x16_bf16 v[112:127], v[44:47], v[36:39], v[112:127]
    s_waitcnt lgkmcnt(6)
    v_mfma_f32_32x32x16_bf16 v[64:79], v[56:59], v[48:51], v[64:79]
    ds_read_b128 v[32:35], v12 offset:256
    ds_read_b64_tr_b16 v[40:41], v14 offset:8192
    ds_read_b64_tr_b16 v[42:43], v14 offset:9216
    v_mfma_f32_32x32x16_bf16 v[80:95], v[56:59], v[52:55], v[80:95]
    ds_read_b128 v[36:39], v12 offset:768
    ds_read_b64_tr_b16 v[44:45], v15 offset:8192
    ds_read_b64_tr_b16 v[46:47], v15 offset:9216
    v_mfma_f32_32x32x16_bf16 v[96:111], v[60:63], v[48:51], v[96:111]
    v_mfma_f32_32x32x16_bf16 v[112:127], v[60:63], v[52:55], v[112:127]
    s_waitcnt lgkmcnt(6)
    v_mfma_f32_32x32x16_bf16 v[64:79], v[24:27], v[16:19], v[64:79]
    ds_read_b128 v[48:51], v13 offset:256
    ds_read_b64_tr_b16 v[56:57], v14 offset:12288
    ds_read_b64_tr_b16 v[58:59], v14 offset:13312
    v_mfma_f32_32x32x16_bf16 v[80:95], v[24:27], v[20:23], v[80:95]
    ds_read_b128 v[52:55], v13 offset:768
    ds_read_b64_tr_b16 v[60:61], v15 offset:12288
    ds_read_b64_tr_b16 v[62:63], v15 offset:13312
    v_mfma_f32_32x32x16_bf16 v[96:111], v[28:31], v[16:19], v[96:111]
    v_mfma_f32_32x32x16_bf16 v[112:127], v[28:31], v[20:23], v[112:127]
    s_waitcnt lgkmcnt(6)
    v_mfma_f32_32x32x16_bf16 v[64:79], v[40:43], v[32:35], v[64:79]
    ds_read_b128 v[16:19], v12 offset:32768
    ds_read_b64_tr_b16 v[24:25], v14 offset:32768
    ds_read_b64_tr_b16 v[26:27], v14 offset:33792
    v_mfma_f32_32x32x16_bf16 v[80:95], v[40:43], v[36:39], v[80:95]
    ds_read_b128 v[20:23], v12 offset:33280
    ds_read_b64_tr_b16 v[28:29], v15 offset:32768
    ds_read_b64_tr_b16 v[30:31], v15 offset:33792
    v_mfma_f32_32x32x16_bf16 v[96:111], v[44:47], v[32:35], v[96:111]
    v_mfma_f32_32x32x16_bf16 v[112:127], v[44:47], v[36:39], v[112:127]
    s_waitcnt lgkmcnt(6)
    v_mfma_f32_32x32x16_bf16 v[64:79], v[56:59], v[48:51], v[64:79]
    ds_read_b128 v[32:35], v13 offset:32768
    ds_read_b64_tr_b16 v[40:41], v14 offset:36864
    ds_read_b64_tr_b16 v[42:43], v14 offset:37888
    v_mfma_f32_32x32x16_bf16 v[80:95], v[56:59], v[52:55], v[80:95]
    ds_read_b128 v[36:39], v13 offset:33280
    ds_read_b64_tr_b16 v[44:45], v15 offset:36864
    ds_read_b64_tr_b16 v[46:47], v15 offset:37888
    v_mfma_f32_32x32x16_bf16 v[96:111], v[60:63], v[48:51], v[96:111]
    v_mfma_f32_32x32x16_bf16 v[112:127], v[60:63], v[52:55], v[112:127]
    s_waitcnt lgkmcnt(6)
    v_mfma_f32_32x32x16_bf16 v[64:79], v[24:27], v[16:19], v[64:79]
    ds_read_b128 v[48:51], v12 offset:33024
    ds_read_b64_tr_b16 v[56:57], v14 offset:40960
    ds_read_b64_tr_b16 v[58:59], v14 offset:41984
    v_mfma_f32_32x32x16_bf16 v[80:95], v[24:27], v[20:23], v[80:95]
    ds_read_b128 v[52:55], v12 offset:33536
    ds_read_b64_tr_b16 v[60:61], v15 offset:40960
    ds_read_b64_tr_b16 v[62:63], v15 offset:41984
    v_mfma_f32_32x32x16_bf16 v[96:111], v[28:31], v[16:19], v[96:111]
    v_mfma_f32_32x32x16_bf16 v[112:127], v[28:31], v[20:23], v[112:127]
    s_waitcnt lgkmcnt(6)
    v_mfma_f32_32x32x16_bf16 v[64:79], v[40:43], v[32:35], v[64:79]
    ds_read_b128 v[16:19], v13 offset:33024
    ds_read_b64_tr_b16 v[24:25], v14 offset:45056
    ds_read_b64_tr_b16 v[26:27], v14 offset:46080
    v_mfma_f32_32x32x16_bf16 v[80:95], v[40:43], v[36:39], v[80:95]
    ds_read_b128 v[20:23], v13 offset:33536
    ds_read_b64_tr_b16 v[28:29], v15 offset:45056
    ds_read_b64_tr_b16 v[30:31], v15 offset:46080
    v_mfma_f32_32x32x16_bf16 v[96:111], v[44:47], v[32:35], v[96:111]
    v_mfma_f32_32x32x16_bf16 v[112:127], v[44:47], v[36:39], v[112:127]
    s_waitcnt lgkmcnt(6)
    v_mfma_f32_32x32x16_bf16 v[64:79], v[56:59], v[48:51], v[64:79]
    v_mfma_f32_32x32x16_bf16 v[80:95], v[56:59], v[52:55], v[80:95]
    v_mfma_f32_32x32x16_bf16 v[96:111], v[60:63], v[48:51], v[96:111]
    v_mfma_f32_32x32x16_bf16 v[112:127], v[60:63], v[52:55], v[112:127]
    s_waitcnt lgkmcnt(0)
    v_mfma_f32_32x32x16_bf16 v[64:79], v[24:27], v[16:19], v[64:79]
    v_mfma_f32_32x32x16_bf16 v[80:95], v[24:27], v[20:23], v[80:95]
    v_mfma_f32_32x32x16_bf16 v[96:111], v[28:31], v[16:19], v[96:111]
    v_mfma_f32_32x32x16_bf16 v[112:127], v[28:31], v[20:23], v[112:127]
    s_lshl_b32 s42, s32, 5
    s_lshr_b32 s34, s8, 1
    s_lshl_b32 s34, s34, 4
    s_add_u32 s42, s42, s34
    s_lshl_b32 s42, s42, 14
    s_lshl_b32 s34, s33, 10
    s_add_u32 s42, s42, s34
    s_and_b32 s34, s8, 1
    s_lshl_b32 s34, s34, 9
    s_add_u32 s42, s42, s34
    v_and_b32 v4, 31, v1
    v_lshrrev_b32 v5, 5, v1
    v_lshlrev_b32 v5, 14, v5
    v_lshl_add_u32 v12, v4, 4, v5
    s_cmp_lt_u32 s32, 5
    s_cselect_b32 s37, 0x3ea52b5c, 1.0
    s_nop 3
    v_mul_f32 v64, s37, v64
    v_mul_f32 v65, s37, v65
    v_mul_f32 v66, s37, v66
    v_mul_f32 v67, s37, v67
    v_mul_f32 v80, s37, v80
    v_mul_f32 v81, s37, v81
    v_mul_f32 v82, s37, v82
    v_mul_f32 v83, s37, v83
    v_cvt_pk_bf16_f32 v16, v64, v65
    v_cvt_pk_bf16_f32 v17, v66, v67
    v_cvt_pk_bf16_f32 v18, v80, v81
    v_cvt_pk_bf16_f32 v19, v82, v83
    s_add_u32 s34, s42, 0
    buffer_store_dwordx4 v[16:19], v12, s[4:7], s34 offen sc1
    v_mul_f32 v68, s37, v68
    v_mul_f32 v69, s37, v69
    v_mul_f32 v70, s37, v70
    v_mul_f32 v71, s37, v71
    v_mul_f32 v84, s37, v84
    v_mul_f32 v85, s37, v85
    v_mul_f32 v86, s37, v86
    v_mul_f32 v87, s37, v87
    v_cvt_pk_bf16_f32 v20, v68, v69
    v_cvt_pk_bf16_f32 v21, v70, v71
    v_cvt_pk_bf16_f32 v22, v84, v85
    v_cvt_pk_bf16_f32 v23, v86, v87
    s_add_u32 s34, s42, 32768
    buffer_store_dwordx4 v[20:23], v12, s[4:7], s34 offen sc1
    v_mul_f32 v72, s37, v72
    v_mul_f32 v73, s37, v73
    v_mul_f32 v74, s37, v74
    v_mul_f32 v75, s37, v75
    v_mul_f32 v88, s37, v88
    v_mul_f32 v89, s37, v89
    v_mul_f32 v90, s37, v90
    v_mul_f32 v91, s37, v91
    v_cvt_pk_bf16_f32 v24, v72, v73
    v_cvt_pk_bf16_f32 v25, v74, v75
    v_cvt_pk_bf16_f32 v26, v88, v89
    v_cvt_pk_bf16_f32 v27, v90, v91
    s_add_u32 s34, s42, 65536
    buffer_store_dwordx4 v[24:27], v12, s[4:7], s34 offen sc1
    v_mul_f32 v76, s37, v76
    v_mul_f32 v77, s37, v77
    v_mul_f32 v78, s37, v78
    v_mul_f32 v79, s37, v79
    v_mul_f32 v92, s37, v92
    v_mul_f32 v93, s37, v93
    v_mul_f32 v94, s37, v94
    v_mul_f32 v95, s37, v95
    v_cvt_pk_bf16_f32 v28, v76, v77
    v_cvt_pk_bf16_f32 v29, v78, v79
    v_cvt_pk_bf16_f32 v30, v92, v93
    v_cvt_pk_bf16_f32 v31, v94, v95
    s_add_u32 s34, s42, 98304
    buffer_store_dwordx4 v[28:31], v12, s[4:7], s34 offen sc1
    v_mul_f32 v96, s37, v96
    v_mul_f32 v97, s37, v97
    v_mul_f32 v98, s37, v98
    v_mul_f32 v99, s37, v99
    v_mul_f32 v112, s37, v112
    v_mul_f32 v113, s37, v113
    v_mul_f32 v114, s37, v114
    v_mul_f32 v115, s37, v115
    v_cvt_pk_bf16_f32 v32, v96, v97
    v_cvt_pk_bf16_f32 v33, v98, v99
    v_cvt_pk_bf16_f32 v34, v112, v113
    v_cvt_pk_bf16_f32 v35, v114, v115
    s_add_u32 s34, s42, 131072
    buffer_store_dwordx4 v[32:35], v12, s[4:7], s34 offen sc1
    v_mul_f32 v100, s37, v100
    v_mul_f32 v101, s37, v101
    v_mul_f32 v102, s37, v102
    v_mul_f32 v103, s37, v103
    v_mul_f32 v116, s37, v116
    v_mul_f32 v117, s37, v117
    v_mul_f32 v118, s37, v118
    v_mul_f32 v119, s37, v119
    v_cvt_pk_bf16_f32 v36, v100, v101
    v_cvt_pk_bf16_f32 v37, v102, v103
    v_cvt_pk_bf16_f32 v38, v116, v117
    v_cvt_pk_bf16_f32 v39, v118, v119
    s_add_u32 s34, s42, 163840
    buffer_store_dwordx4 v[36:39], v12, s[4:7], s34 offen sc1
    v_mul_f32 v104, s37, v104
    v_mul_f32 v105, s37, v105
    v_mul_f32 v106, s37, v106
    v_mul_f32 v107, s37, v107
    v_mul_f32 v120, s37, v120
    v_mul_f32 v121, s37, v121
    v_mul_f32 v122, s37, v122
    v_mul_f32 v123, s37, v123
    v_cvt_pk_bf16_f32 v40, v104, v105
    v_cvt_pk_bf16_f32 v41, v106, v107
    v_cvt_pk_bf16_f32 v42, v120, v121
    v_cvt_pk_bf16_f32 v43, v122, v123
    s_add_u32 s34, s42, 196608
    buffer_store_dwordx4 v[40:43], v12, s[4:7], s34 offen sc1
    v_mul_f32 v108, s37, v108
    v_mul_f32 v109, s37, v109
    v_mul_f32 v110, s37, v110
    v_mul_f32 v111, s37, v111
    v_mul_f32 v124, s37, v124
    v_mul_f32 v125, s37, v125
    v_mul_f32 v126, s37, v126
    v_mul_f32 v127, s37, v127
    v_cvt_pk_bf16_f32 v44, v108, v109
    v_cvt_pk_bf16_f32 v45, v110, v111
    v_cvt_pk_bf16_f32 v46, v124, v125
    v_cvt_pk_bf16_f32 v47, v126, v127
    s_add_u32 s34, s42, 229376
    buffer_store_dwordx4 v[44:47], v12, s[4:7], s34 offen sc1
    s_waitcnt vmcnt(0)
    v_mov_b32 v2, 163776
    v_mov_b32 v3, 1
    s_mov_b64 s[94:95], exec
    s_mov_b64 exec, 1
    ds_add_rtn_u32 v3, v2, v3 offset:20
    s_waitcnt lgkmcnt(0)
    v_readfirstlane_b32 s93, v3
    s_mov_b64 exec, s[94:95]
    s_cmp_eq_u32 s93, 3
    s_cbranch_scc0 L_nl_6
    s_lshl_b32 s92, s32, 8
    s_add_u32 s92, s92, 50331648
    v_mov_b32 v2, 0
    v_mov_b32 v3, 1
    s_mov_b64 s[94:95], exec
    s_mov_b64 exec, 1
    buffer_atomic_add v3, v2, s[4:7], s92 offen
    s_mov_b64 exec, s[94:95]
L_nl_6:
    s_cmp_eq_u32 s8, 0
    s_cbranch_scc1 L_nfs_7
    s_and_b32 s34, s2, 7
    s_add_u32 s34, s34, 40
    v_mov_b32 v2, 163776
    v_mov_b32 v3, 1
    s_mov_b64 s[94:95], exec
    s_mov_b64 exec, 1
    ds_add_rtn_u32 v3, v2, v3 offset:24
    s_waitcnt lgkmcnt(0)
    v_readfirstlane_b32 s93, v3
    s_mov_b64 exec, s[94:95]
    s_cmp_eq_u32 s93, 2
    s_cbranch_scc0 L_nl_8
    s_lshl_b32 s92, s34, 8
    s_add_u32 s92, s92, 50331648
    v_mov_b32 v2, 0
    v_mov_b32 v3, 1
    s_mov_b64 s[94:95], exec
    s_mov_b64 exec, 1
    buffer_atomic_add v3, v2, s[4:7], s92 offen
    s_mov_b64 exec, s[94:95]
L_nl_8:
L_nfs_7:
    s_branch L_p1_end
L_p1_idle:
    s_waitcnt lgkmcnt(0)
    buffer_store_dwordx4 v[144:147], v140, s[4:7], 0 offen sc1
    buffer_store_dwordx4 v[148:151], v141, s[4:7], 0 offen sc1
    buffer_store_dwordx4 v[152:155], v142, s[4:7], 0 offen sc1
    s_waitcnt vmcnt(0)
    s_barrier
    s_barrier
    s_barrier
    s_barrier
    s_barrier
    s_barrier
    s_barrier
    s_barrier
    s_mov_b32 s12, s68
    s_and_b32 s13, s69, 0xffff
    s_mov_b32 s14, 819200
    s_mov_b32 s15, 0x20000
    s_bfe_u32 s33, s2, 0x40001
    s_lshr_b32 s36, s33, 1
    s_and_b32 s33, s33, 1
    s_mul_i32 s33, s33, 10
    s_mul_i32 s35, s36, 160
    v_add_u32 v4, 0, v1
    v_mul_u32_u24 v5, 6554, v4
    v_lshrrev_b32 v5, 16, v5
    v_mul_u32_u24 v7, 10, v5
    v_sub_u32 v6, v4, v7
    v_mul_u32_u24 v16, 1280, v5
    v_lshl_add_u32 v16, v6, 4, v16
    v_add_u32 v16, s35, v16
    v_add_u32 v4, 64, v1
    v_mul_u32_u24 v5, 6554, v4
    v_lshrrev_b32 v5, 16, v5
    v_mul_u32_u24 v7, 10, v5
    v_sub_u32 v6, v4, v7
    v_mul_u32_u24 v17, 1280, v5
    v_lshl_add_u32 v17, v6, 4, v17
    v_add_u32 v17, s35, v17
    v_add_u32 v4, 128, v1
    v_mul_u32_u24 v5, 6554, v4
    v_lshrrev_b32 v5, 16, v5
    v_mul_u32_u24 v7, 10, v5
    v_sub_u32 v6, v4, v7
    v_mul_u32_u24 v18, 1280, v5
    v_lshl_add_u32 v18, v6, 4, v18
    v_add_u32 v18, s35, v18
    v_add_u32 v4, 192, v1
    v_mul_u32_u24 v5, 6554, v4
    v_lshrrev_b32 v5, 16, v5
    v_mul_u32_u24 v7, 10, v5
    v_sub_u32 v6, v4, v7
    v_mul_u32_u24 v19, 1280, v5
    v_lshl_add_u32 v19, v6, 4, v19
    v_add_u32 v19, s35, v19
    v_add_u32 v4, 256, v1
    v_mul_u32_u24 v5, 6554, v4
    v_lshrrev_b32 v5, 16, v5
    v_mul_u32_u24 v7, 10, v5
    v_sub_u32 v6, v4, v7
    v_mul_u32_u24 v20, 1280, v5
    v_lshl_add_u32 v20, v6, 4, v20
    v_add_u32 v20, s35, v20
    s_mul_i32 s42, s8, 15360
    v_lshrrev_b32 v4, 4, v1
    v_lshlrev_b32 v4, 2, v4
    v_bfe_u32 v5, v1, 2, 2
    v_add_u32 v4, v4, v5
    v_mul_u32_u24 v21, 160, v4
    v_and_b32 v5, 3, v1
    v_lshl_add_u32 v21, v5, 3, v21
    v_add_u32 v21, s42, v21
    v_lshlrev_b32 v22, 4, v1
    s_add_u32 s34, s8, 0
    s_min_u32 s34, s34, 9
    s_add_u32 s34, s34, s33
    s_mul_i32 s35, s34, 40960
    s_add_u32 m0, s42, 0
    s_nop 0
    buffer_load_dwordx4 v16, s[12:15], s35 offen lds
    s_add_u32 m0, s42, 1024
    s_nop 0
    buffer_load_dwordx4 v17, s[12:15], s35 offen lds
    s_add_u32 m0, s42, 2048
    s_nop 0
    buffer_load_dwordx4 v18, s[12:15], s35 offen lds
    s_add_u32 m0, s42, 3072
    s_nop 0
    buffer_load_dwordx4 v19, s[12:15], s35 offen lds
    s_add_u32 m0, s42, 4096
    s_nop 0
    buffer_load_dwordx4 v20, s[12:15], s35 offen lds
    s_add_u32 s34, s8, 4
    s_min_u32 s34, s34, 9
    s_add_u32 s34, s34, s33
    s_mul_i32 s35, s34, 40960
    s_add_u32 m0, s42, 5120
    s_nop 0
    buffer_load_dwordx4 v16, s[12:15], s35 offen lds
    s_add_u32 m0, s42, 6144
    s_nop 0
    buffer_load_dwordx4 v17, s[12:15], s35 offen lds
    s_add_u32 m0, s42, 7168
    s_nop 0
    buffer_load_dwordx4 v18, s[12:15], s35 offen lds
    s_add_u32 m0, s42, 8192
    s_nop 0
    buffer_load_dwordx4 v19, s[12:15], s35 offen lds
    s_add_u32 m0, s42, 9216
    s_nop 0
    buffer_load_dwordx4 v20, s[12:15], s35 offen lds
    s_add_u32 s34, s8, 8
    s_min_u32 s34, s34, 9
    s_add_u32 s34, s34, s33
    s_mul_i32 s35, s34, 40960
    s_add_u32 m0, s42, 10240
    s_nop 0
    buffer_load_dwordx4 v16, s[12:15], s35 offen lds
    s_add_u32 m0, s42, 11264
    s_nop 0
    buffer_load_dwordx4 v17, s[12:15], s35 offen lds
    s_add_u32 m0, s42, 12288
    s_nop 0
    buffer_load_dwordx4 v18, s[12:15], s35 offen lds
    s_add_u32 m0, s42, 13312
    s_nop 0
    buffer_load_dwordx4 v19, s[12:15], s35 offen lds
    s_add_u32 m0, s42, 14336
    s_nop 0
    buffer_load_dwordx4 v20, s[12:15], s35 offen lds
    s_waitcnt vmcnt(0)
    ds_read_b64_tr_b16 v[64:65], v21 offset:0
    ds_read_b64_tr_b16 v[66:67], v21 offset:2560
    ds_read_b64_tr_b16 v[68:69], v21 offset:32
    ds_read_b64_tr_b16 v[70:71], v21 offset:2592
    ds_read_b64_tr_b16 v[72:73], v21 offset:64
    ds_read_b64_tr_b16 v[74:75], v21 offset:2624
    ds_read_b64_tr_b16 v[76:77], v21 offset:96
    ds_read_b64_tr_b16 v[78:79], v21 offset:2656
    ds_read_b64_tr_b16 v[80:81], v21 offset:128
    ds_read_b64_tr_b16 v[82:83], v21 offset:2688
    s_waitcnt lgkmcnt(0)
    ds_read_b64_tr_b16 v[84:85], v21 offset:5120
    ds_read_b64_tr_b16 v[86:87], v21 offset:7680
    ds_read_b64_tr_b16 v[88:89], v21 offset:5152
    ds_read_b64_tr_b16 v[90:91], v21 offset:7712
    ds_read_b64_tr_b16 v[92:93], v21 offset:5184
    ds_read_b64_tr_b16 v[94:95], v21 offset:7744
    ds_read_b64_tr_b16 v[96:97], v21 offset:5216
    ds_read_b64_tr_b16 v[98:99], v21 offset:7776
    ds_read_b64_tr_b16 v[100:101], v21 offset:5248
    ds_read_b64_tr_b16 v[102:103], v21 offset:7808
    s_waitcnt lgkmcnt(0)
    ds_read_b64_tr_b16 v[104:105], v21 offset:10240
    ds_read_b64_tr_b16 v[106:107], v21 offset:12800
    ds_read_b64_tr_b16 v[108:109], v21 offset:10272
    ds_read_b64_tr_b16 v[110:111], v21 offset:12832
    ds_read_b64_tr_b16 v[112:113], v21 offset:10304
    ds_read_b64_tr_b16 v[114:115], v21 offset:12864
    ds_read_b64_tr_b16 v[116:117], v21 offset:10336
    ds_read_b64_tr_b16 v[118:119], v21 offset:12896
    ds_read_b64_tr_b16 v[120:121], v21 offset:10368
    ds_read_b64_tr_b16 v[122:123], v21 offset:12928
    s_waitcnt lgkmcnt(0)
    s_add_u32 s34, s8, 0
    s_min_u32 s34, s34, 9
    s_add_u32 s34, s34, s33
    s_mul_i32 s35, s36, 20
    s_add_u32 s34, s34, s35
    s_mul_i32 s34, s34, 5120
    s_add_u32 s34, s34, 22020096
    buffer_store_dwordx4 v[64:67], v22, s[4:7], s34 offen offset:0 sc1
    buffer_store_dwordx4 v[68:71], v22, s[4:7], s34 offen offset:1024 sc1
    buffer_store_dwordx4 v[72:75], v22, s[4:7], s34 offen offset:2048 sc1
    buffer_store_dwordx4 v[76:79], v22, s[4:7], s34 offen offset:3072 sc1
    s_add_u32 s34, s34, 4096
    buffer_store_dwordx4 v[80:83], v22, s[4:7], s34 offen offset:0 sc1
    s_add_u32 s34, s8, 4
    s_min_u32 s34, s34, 9
    s_add_u32 s34, s34, s33
    s_mul_i32 s35, s36, 20
    s_add_u32 s34, s34, s35
    s_mul_i32 s34, s34, 5120
    s_add_u32 s34, s34, 22020096
    buffer_store_dwordx4 v[84:87], v22, s[4:7], s34 offen offset:0 sc1
    buffer_store_dwordx4 v[88:91], v22, s[4:7], s34 offen offset:1024 sc1
    buffer_store_dwordx4 v[92:95], v22, s[4:7], s34 offen offset:2048 sc1
    buffer_store_dwordx4 v[96:99], v22, s[4:7], s34 offen offset:3072 sc1
    s_add_u32 s34, s34, 4096
    buffer_store_dwordx4 v[100:103], v22, s[4:7], s34 offen offset:0 sc1
    s_add_u32 s34, s8, 8
    s_min_u32 s34, s34, 9
    s_add_u32 s34, s34, s33
    s_mul_i32 s35, s36, 20
    s_add_u32 s34, s34, s35
    s_mul_i32 s34, s34, 5120
    s_add_u32 s34, s34, 22020096
    buffer_store_dwordx4 v[104:107], v22, s[4:7], s34 offen offset:0 sc1
    buffer_store_dwordx4 v[108:111], v22, s[4:7], s34 offen offset:1024 sc1
    buffer_store_dwordx4 v[112:115], v22, s[4:7], s34 offen offset:2048 sc1
    buffer_store_dwordx4 v[116:119], v22, s[4:7], s34 offen offset:3072 sc1
    s_add_u32 s34, s34, 4096
    buffer_store_dwordx4 v[120:123], v22, s[4:7], s34 offen offset:0 sc1
    s_cmp_eq_u32 s8, 0
    s_cbranch_scc1 L_nf_9
    v_mov_b32 v160, -1
    v_mov_b32 v161, -1
    v_mov_b32 v162, -1
    v_mov_b32 v163, -1
    v_lshlrev_b32 v164, 4, v1
    s_and_b32 s34, s2, 7
    s_lshl_b32 s34, s34, 2
    s_bfe_u32 s35, s2, 0x20003
    s_add_u32 s34, s34, s35
    s_mul_i32 s34, s34, 81920
    s_lshr_b32 s35, s2, 5
    s_mul_i32 s35, s35, 10240
    s_add_u32 s34, s34, s35
    s_add_u32 s34, s34, 8388608
    s_sub_u32 s35, s8, 1
    s_lshl_b32 s35, s35, 12
    s_min_u32 s35, s35, 6144
    s_add_u32 s34, s34, s35
    buffer_store_dwordx4 v[160:163], v164, s[4:7], s34 offen offset:0 sc1
    buffer_store_dwordx4 v[160:163], v164, s[4:7], s34 offen offset:1024 sc1
    buffer_store_dwordx4 v[160:163], v164, s[4:7], s34 offen offset:2048 sc1
    buffer_store_dwordx4 v[160:163], v164, s[4:7], s34 offen offset:3072 sc1
L_nf_9:
    s_waitcnt vmcnt(0)
    s_mov_b32 s34, 15
    s_lshl_b32 s92, s34, 8
    s_add_u32 s92, s92, 50331648
    v_mov_b32 v2, 0
    v_mov_b32 v3, 1
    s_mov_b64 s[94:95], exec
    s_mov_b64 exec, 1
    buffer_atomic_add v3, v2, s[4:7], s92 offen
    s_mov_b64 exec, s[94:95]
    s_cmp_eq_u32 s8, 0
    s_cbranch_scc1 L_nfs_10
    s_and_b32 s34, s2, 7
    s_add_u32 s34, s34, 40
    v_mov_b32 v2, 163776
    v_mov_b32 v3, 1
    s_mov_b64 s[94:95], exec
    s_mov_b64 exec, 1
    ds_add_rtn_u32 v3, v2, v3 offset:24
    s_waitcnt lgkmcnt(0)
    v_readfirstlane_b32 s93, v3
    s_mov_b64 exec, s[94:95]
    s_cmp_eq_u32 s93, 2
    s_cbranch_scc0 L_nl_11
    s_lshl_b32 s92, s34, 8
    s_add_u32 s92, s92, 50331648
    v_mov_b32 v2, 0
    v_mov_b32 v3, 1
    s_mov_b64 s[94:95], exec
    s_mov_b64 exec, 1
    buffer_atomic_add v3, v2, s[4:7], s92 offen
    s_mov_b64 exec, s[94:95]
L_nl_11:
L_nfs_10:
    s_branch L_p1_end
L_attn_grpB:
    s_setprio 1
    .p2align 6
L_attn_loopB:
    s_waitcnt lgkmcnt(3)
    v_mfma_f32_32x32x16_bf16 v[100:115], v[32:35], v[24:27], 0
    v_exp_f32 v68, v68
    v_cvt_pk_bf16_f32 v67, v130, v131
    v_exp_f32 v69, v69
    v_exp_f32 v70, v70
    v_cvt_pk_bf16_f32 v52, v68, v69
    v_exp_f32 v71, v71
    v_mfma_f32_32x32x16_bf16 v[148:163], v[48:51], v[64:67], v[148:163]
    ds_read_b64_tr_b16 v[48:49], v6 offset:128
    ds_read_b64_tr_b16 v[50:51], v6 offset:192
    v_exp_f32 v72, v72
    v_cvt_pk_bf16_f32 v53, v70, v71
    v_exp_f32 v73, v73
    v_exp_f32 v74, v74
    v_cvt_pk_bf16_f32 v54, v72, v73
    v_exp_f32 v75, v75
    v_mfma_f32_32x32x16_bf16 v[116:131], v[32:35], v[28:31], 0
    ds_read_b64 v[32:33], v4 offset:512
    ds_read_b64 v[34:35], v4 offset:1568
    v_exp_f32 v76, v76
    v_cvt_pk_bf16_f32 v55, v74, v75
    v_exp_f32 v77, v77
    v_exp_f32 v78, v78
    v_cvt_pk_bf16_f32 v56, v76, v77
    v_exp_f32 v79, v79
    s_waitcnt lgkmcnt(4)
    v_mfma_f32_32x32x16_bf16 v[132:147], v[44:47], v[52:55], v[132:147]
    v_exp_f32 v80, v80
    v_cvt_pk_bf16_f32 v57, v78, v79
    v_exp_f32 v81, v81
    v_exp_f32 v82, v82
    v_cvt_pk_bf16_f32 v58, v80, v81
    v_exp_f32 v83, v83
    v_mfma_f32_32x32x8_bf16 v[100:115], v[40:41], v[36:37], v[100:115]
    v_exp_f32 v84, v84
    v_cvt_pk_bf16_f32 v59, v82, v83
    v_exp_f32 v85, v85
    v_exp_f32 v86, v86
    v_cvt_pk_bf16_f32 v60, v84, v85
    v_exp_f32 v87, v87
    s_waitcnt lgkmcnt(2)
    v_mfma_f32_32x32x16_bf16 v[132:147], v[48:51], v[56:59], v[132:147]
    v_exp_f32 v88, v88
    v_cvt_pk_bf16_f32 v61, v86, v87
    v_exp_f32 v89, v89
    v_exp_f32 v90, v90
    v_cvt_pk_bf16_f32 v62, v88, v89
    v_exp_f32 v91, v91
    v_mfma_f32_32x32x8_bf16 v[116:131], v[40:41], v[38:39], v[116:131]
    ds_read_b64 v[40:41], v5 offset:512
    v_exp_f32 v92, v92
    v_cvt_pk_bf16_f32 v63, v90, v91
    v_exp_f32 v93, v93
    v_exp_f32 v94, v94
    v_cvt_pk_bf16_f32 v64, v92, v93
    v_exp_f32 v95, v95
    v_mfma_f32_32x32x16_bf16 v[148:163], v[44:47], v[60:63], v[148:163]
    ds_read_b64_tr_b16 v[44:45], v6 offset:256
    ds_read_b64_tr_b16 v[46:47], v6 offset:320
    v_exp_f32 v96, v96
    v_cvt_pk_bf16_f32 v65, v94, v95
    v_exp_f32 v97, v97
    v_exp_f32 v98, v98
    v_cvt_pk_bf16_f32 v66, v96, v97
    v_exp_f32 v99, v99
    s_waitcnt lgkmcnt(3)
    v_mfma_f32_32x32x16_bf16 v[68:83], v[32:35], v[24:27], 0
    v_exp_f32 v100, v100
    v_cvt_pk_bf16_f32 v67, v98, v99
    v_exp_f32 v101, v101
    v_exp_f32 v102, v102
    v_cvt_pk_bf16_f32 v52, v100, v101
    v_exp_f32 v103, v103
    v_mfma_f32_32x32x16_bf16 v[148:163], v[48:51], v[64:67], v[148:163]
    ds_read_b64_tr_b16 v[48:49], v6 offset:384
    ds_read_b64_tr_b16 v[50:51], v6 offset:448
    v_exp_f32 v104, v104
    v_cvt_pk_bf16_f32 v53, v102, v103
    v_exp_f32 v105, v105
    v_exp_f32 v106, v106
    v_cvt_pk_bf16_f32 v54, v104, v105
    v_exp_f32 v107, v107
    v_mfma_f32_32x32x16_bf16 v[84:99], v[32:35], v[28:31], 0
    ds_read_b64 v[32:33], v4 offset:768
    ds_read_b64 v[34:35], v4 offset:1824
    v_exp_f32 v108, v108
    v_cvt_pk_bf16_f32 v55, v106, v107
    v_exp_f32 v109, v109
    v_exp_f32 v110, v110
    v_cvt_pk_bf16_f32 v56, v108, v109
    v_exp_f32 v111, v111
    s_waitcnt lgkmcnt(4)
    v_mfma_f32_32x32x16_bf16 v[132:147], v[44:47], v[52:55], v[132:147]
    v_exp_f32 v112, v112
    v_cvt_pk_bf16_f32 v57, v110, v111
    v_exp_f32 v113, v113
    v_exp_f32 v114, v114
    v_cvt_pk_bf16_f32 v58, v112, v113
    v_exp_f32 v115, v115
    v_mfma_f32_32x32x8_bf16 v[68:83], v[40:41], v[36:37], v[68:83]
    v_exp_f32 v116, v116
    v_cvt_pk_bf16_f32 v59, v114, v115
    v_exp_f32 v117, v117
    v_exp_f32 v118, v118
    v_cvt_pk_bf16_f32 v60, v116, v117
    v_exp_f32 v119, v119
    s_waitcnt lgkmcnt(2)
    v_mfma_f32_32x32x16_bf16 v[132:147], v[48:51], v[56:59], v[132:147]
    v_exp_f32 v120, v120
    v_cvt_pk_bf16_f32 v61, v118, v119
    v_exp_f32 v121, v121
    v_exp_f32 v122, v122
    v_cvt_pk_bf16_f32 v62, v120, v121
    v_exp_f32 v123, v123
    v_mfma_f32_32x32x8_bf16 v[84:99], v[40:41], v[38:39], v[84:99]
    ds_read_b64 v[40:41], v5 offset:768
    v_exp_f32 v124, v124
    v_cvt_pk_bf16_f32 v63, v122, v123
    v_exp_f32 v125, v125
    v_exp_f32 v126, v126
    v_cvt_pk_bf16_f32 v64, v124, v125
    v_exp_f32 v127, v127
    v_mfma_f32_32x32x16_bf16 v[148:163], v[44:47], v[60:63], v[148:163]
    ds_read_b64_tr_b16 v[44:45], v6 offset:512
    ds_read_b64_tr_b16 v[46:47], v6 offset:576
    v_exp_f32 v128, v128
    v_cvt_pk_bf16_f32 v65, v126, v127
    v_exp_f32 v129, v129
    v_exp_f32 v130, v130
    v_cvt_pk_bf16_f32 v66, v128, v129
    v_exp_f32 v131, v131
    s_waitcnt lgkmcnt(3)
    v_mfma_f32_32x32x16_bf16 v[100:115], v[32:35], v[24:27], 0
    v_exp_f32 v68, v68
    v_cvt_pk_bf16_f32 v67, v130, v131
    v_exp_f32 v69, v69
    v_exp_f32 v70, v70
    v_cvt_pk_bf16_f32 v52, v68, v69
    v_exp_f32 v71, v71
    v_mfma_f32_32x32x16_bf16 v[148:163], v[48:51], v[64:67], v[148:163]
    ds_read_b64_tr_b16 v[48:49], v6 offset:640
    ds_read_b64_tr_b16 v[50:51], v6 offset:704
    v_exp_f32 v72, v72
    v_cvt_pk_bf16_f32 v53, v70, v71
    v_exp_f32 v73, v73
    v_exp_f32 v74, v74
    v_cvt_pk_bf16_f32 v54, v72, v73
    v_exp_f32 v75, v75
    v_mfma_f32_32x32x16_bf16 v[116:131], v[32:35], v[28:31], 0
    s_waitcnt vmcnt(0)
    s_barrier
    s_cmp_eq_u32 s19, 1
    s_cselect_b32 s14, s39, 0
    s_cmp_eq_u32 s14, 0
    s_cbranch_scc1 L_zs_57
    v_mov_b32 v2, 0
    v_mov_b32 v3, 1
    s_mov_b64 exec, 1
    buffer_atomic_add v3, v2, s[4:7], s38 offen
    s_mov_b64 exec, -1
L_zs_57:
    ds_read_b64 v[32:33], v4 offset:25344
    ds_read_b64 v[34:35], v4 offset:26400
    s_cmp_eq_u32 s19, 3
    s_cbranch_scc1 L_nd_58
    s_add_u32 s14, s27, s13
    s_mov_b32 m0, s14
    s_add_u32 s24, s24, 1024
    s_sub_u32 s14, s24, 1024
    buffer_load_dwordx4 v17, s[4:7], s14 offen lds
L_nd_58:
    v_exp_f32 v76, v76
    v_cvt_pk_bf16_f32 v55, v74, v75
    v_exp_f32 v77, v77
    v_exp_f32 v78, v78
    v_cvt_pk_bf16_f32 v56, v76, v77
    v_exp_f32 v79, v79
    s_waitcnt lgkmcnt(4)
    v_mfma_f32_32x32x16_bf16 v[132:147], v[44:47], v[52:55], v[132:147]
    v_exp_f32 v80, v80
    v_cvt_pk_bf16_f32 v57, v78, v79
    v_exp_f32 v81, v81
    v_exp_f32 v82, v82
    v_cvt_pk_bf16_f32 v58, v80, v81
    v_exp_f32 v83, v83
    v_mfma_f32_32x32x8_bf16 v[100:115], v[40:41], v[36:37], v[100:115]
    v_exp_f32 v84, v84
    v_cvt_pk_bf16_f32 v59, v82, v83
    v_exp_f32 v85, v85
    v_exp_f32 v86, v86
    v_cvt_pk_bf16_f32 v60, v84, v85
    v_exp_f32 v87, v87
    s_waitcnt lgkmcnt(2)
    v_mfma_f32_32x32x16_bf16 v[132:147], v[48:51], v[56:59], v[132:147]
    v_exp_f32 v88, v88
    v_cvt_pk_bf16_f32 v61, v86, v87
    v_exp_f32 v89, v89
    v_exp_f32 v90, v90
    v_cvt_pk_bf16_f32 v62, v88, v89
    v_exp_f32 v91, v91
    v_mfma_f32_32x32x8_bf16 v[116:131], v[40:41], v[38:39], v[116:131]
    ds_read_b64 v[40:41], v5 offset:25344
    v_exp_f32 v92, v92
    v_cvt_pk_bf16_f32 v63, v90, v91
    v_exp_f32 v93, v93
    v_exp_f32 v94, v94
    v_cvt_pk_bf16_f32 v64, v92, v93
    v_exp_f32 v95, v95
    v_mfma_f32_32x32x16_bf16 v[148:163], v[44:47], v[60:63], v[148:163]
    ds_read_b64_tr_b16 v[44:45], v6 offset:768
    ds_read_b64_tr_b16 v[46:47], v6 offset:832
    v_exp_f32 v96, v96
    v_cvt_pk_bf16_f32 v65, v94, v95
    v_exp_f32 v97, v97
    v_exp_f32 v98, v98
    v_cvt_pk_bf16_f32 v66, v96, v97
    v_exp_f32 v99, v99
    s_waitcnt lgkmcnt(3)
    v_mfma_f32_32x32x16_bf16 v[68:83], v[32:35], v[24:27], 0
    v_exp_f32 v100, v100
    v_cvt_pk_bf16_f32 v67, v98, v99
    v_exp_f32 v101, v101
    v_exp_f32 v102, v102
    v_cvt_pk_bf16_f32 v52, v100, v101
    v_exp_f32 v103, v103
    v_mfma_f32_32x32x16_bf16 v[148:163], v[48:51], v[64:67], v[148:163]
    ds_read_b64_tr_b16 v[48:49], v6 offset:896
    ds_read_b64_tr_b16 v[50:51], v6 offset:960
    v_exp_f32 v104, v104
    v_cvt_pk_bf16_f32 v53, v102, v103
    v_exp_f32 v105, v105
    v_exp_f32 v106, v106
    v_cvt_pk_bf16_f32 v54, v104, v105
    v_exp_f32 v107, v107
    v_mfma_f32_32x32x16_bf16 v[84:99], v[32:35], v[28:31], 0
    ds_read_b64 v[32:33], v4 offset:25600
    ds_read_b64 v[34:35], v4 offset:26656
    s_cmp_eq_u32 s19, 3
    s_cbranch_scc1 L_nd_59
    s_add_u32 s14, s28, s13
    s_mov_b32 m0, s14
    s_add_u32 s25, s25, 1024
    s_sub_u32 s14, s25, 1024
    buffer_load_dwordx4 v17, s[4:7], s14 offen lds
L_nd_59:
    v_exp_f32 v108, v108
    v_cvt_pk_bf16_f32 v55, v106, v107
    v_exp_f32 v109, v109
    v_exp_f32 v110, v110
    v_cvt_pk_bf16_f32 v56, v108, v109
    v_exp_f32 v111, v111
    s_waitcnt lgkmcnt(4)
    v_mfma_f32_32x32x16_bf16 v[132:147], v[44:47], v[52:55], v[132:147]
    v_exp_f32 v112, v112
    v_cvt_pk_bf16_f32 v57, v110, v111
    v_exp_f32 v113, v113
    v_exp_f32 v114, v114
    v_cvt_pk_bf16_f32 v58, v112, v113
    v_exp_f32 v115, v115
    v_mfma_f32_32x32x8_bf16 v[68:83], v[40:41], v[36:37], v[68:83]
    v_exp_f32 v116, v116
    v_cvt_pk_bf16_f32 v59, v114, v115
    v_exp_f32 v117, v117
    v_exp_f32 v118, v118
    v_cvt_pk_bf16_f32 v60, v116, v117
    v_exp_f32 v119, v119
    s_waitcnt lgkmcnt(2)
    v_mfma_f32_32x32x16_bf16 v[132:147], v[48:51], v[56:59], v[132:147]
    v_exp_f32 v120, v120
    v_cvt_pk_bf16_f32 v61, v118, v119
    v_exp_f32 v121, v121
    v_exp_f32 v122, v122
    v_cvt_pk_bf16_f32 v62, v120, v121
    v_exp_f32 v123, v123
    v_mfma_f32_32x32x8_bf16 v[84:99], v[40:41], v[38:39], v[84:99]
    ds_read_b64 v[40:41], v5 offset:25600
    v_exp_f32 v124, v124
    v_cvt_pk_bf16_f32 v63, v122, v123
    v_exp_f32 v125, v125
    v_exp_f32 v126, v126
    v_cvt_pk_bf16_f32 v64, v124, v125
    v_exp_f32 v127, v127
    v_mfma_f32_32x32x16_bf16 v[148:163], v[44:47], v[60:63], v[148:163]
    ds_read_b64_tr_b16 v[44:45], v6 offset:25344
    ds_read_b64_tr_b16 v[46:47], v6 offset:25408
    v_exp_f32 v128, v128
    v_cvt_pk_bf16_f32 v65, v126, v127
    v_exp_f32 v129, v129
    v_exp_f32 v130, v130
    v_cvt_pk_bf16_f32 v66, v128, v129
    v_exp_f32 v131, v131
    s_waitcnt lgkmcnt(3)
    v_mfma_f32_32x32x16_bf16 v[100:115], v[32:35], v[24:27], 0
    v_exp_f32 v68, v68
    v_cvt_pk_bf16_f32 v67, v130, v131
    v_exp_f32 v69, v69
    v_exp_f32 v70, v70
    v_cvt_pk_bf16_f32 v52, v68, v69
    v_exp_f32 v71, v71
    v_mfma_f32_32x32x16_bf16 v[148:163], v[48:51], v[64:67], v[148:163]
    ds_read_b64_tr_b16 v[48:49], v6 offset:25472
    ds_read_b64_tr_b16 v[50:51], v6 offset:25536
    v_exp_f32 v72, v72
    v_cvt_pk_bf16_f32 v53, v70, v71
    v_exp_f32 v73, v73
    v_exp_f32 v74, v74
    v_cvt_pk_bf16_f32 v54, v72, v73
    v_exp_f32 v75, v75
    v_mfma_f32_32x32x16_bf16 v[116:131], v[32:35], v[28:31], 0
    ds_read_b64 v[32:33], v4 offset:25856
    ds_read_b64 v[34:35], v4 offset:26912
    v_exp_f32 v76, v76
    v_cvt_pk_bf16_f32 v55, v74, v75
    v_exp_f32 v77, v77
    v_exp_f32 v78, v78
    v_cvt_pk_bf16_f32 v56, v76, v77
    v_exp_f32 v79, v79
    s_waitcnt lgkmcnt(4)
    v_mfma_f32_32x32x16_bf16 v[132:147], v[44:47], v[52:55], v[132:147]
    v_exp_f32 v80, v80
    v_cvt_pk_bf16_f32 v57, v78, v79
    v_exp_f32 v81, v81
    v_exp_f32 v82, v82
    v_cvt_pk_bf16_f32 v58, v80, v81
    v_exp_f32 v83, v83
    v_mfma_f32_32x32x8_bf16 v[100:115], v[40:41], v[36:37], v[100:115]
    v_exp_f32 v84, v84
    v_cvt_pk_bf16_f32 v59, v82, v83
    v_exp_f32 v85, v85
    v_exp_f32 v86, v86
    v_cvt_pk_bf16_f32 v60, v84, v85
    v_exp_f32 v87, v87
    s_waitcnt lgkmcnt(2)
    v_mfma_f32_32x32x16_bf16 v[132:147], v[48:51], v[56:59], v[132:147]
    v_exp_f32 v88, v88
    v_cvt_pk_bf16_f32 v61, v86, v87
    v_exp_f32 v89, v89
    v_exp_f32 v90, v90
    v_cvt_pk_bf16_f32 v62, v88, v89
    v_exp_f32 v91, v91
    v_mfma_f32_32x32x8_bf16 v[116:131], v[40:41], v[38:39], v[116:131]
    ds_read_b64 v[40:41], v5 offset:25856
    v_exp_f32 v92, v92
    v_cvt_pk_bf16_f32 v63, v90, v91
    v_exp_f32 v93, v93
    v_exp_f32 v94, v94
    v_cvt_pk_bf16_f32 v64, v92, v93
    v_exp_f32 v95, v95
    v_mfma_f32_32x32x16_bf16 v[148:163], v[44:47], v[60:63], v[148:163]
    ds_read_b64_tr_b16 v[44:45], v6 offset:25600
    ds_read_b64_tr_b16 v[46:47], v6 offset:25664
    v_exp_f32 v96, v96
    v_cvt_pk_bf16_f32 v65, v94, v95
    v_exp_f32 v97, v97
    v_exp_f32 v98, v98
    v_cvt_pk_bf16_f32 v66, v96, v97
    v_exp_f32 v99, v99
    s_waitcnt lgkmcnt(3)
    v_mfma_f32_32x32x16_bf16 v[68:83], v[32:35], v[24:27], 0
    v_exp_f32 v100, v100
    v_cvt_pk_bf16_f32 v67, v98, v99
    v_exp_f32 v101, v101
    v_exp_f32 v102, v102
    v_cvt_pk_bf16_f32 v52, v100, v101
    v_exp_f32 v103, v103
    v_mfma_f32_32x32x16_bf16 v[148:163], v[48:51], v[64:67], v[148:163]
    ds_read_b64_tr_b16 v[48:49], v6 offset:25728
    ds_read_b64_tr_b16 v[50:51], v6 offset:25792
    v_exp_f32 v104, v104
    v_cvt_pk_bf16_f32 v53, v102, v103
    v_exp_f32 v105, v105
    v_exp_f32 v106, v106
    v_cvt_pk_bf16_f32 v54, v104, v105
    v_exp_f32 v107, v107
    v_mfma_f32_32x32x16_bf16 v[84:99], v[32:35], v[28:31], 0
    ds_read_b64 v[32:33], v4 offset:26112
    ds_read_b64 v[34:35], v4 offset:27168
    buffer_load_dword v11, v12, s[4:7], s35 offen sc1
    v_exp_f32 v108, v108
    v_cvt_pk_bf16_f32 v55, v106, v107
    v_exp_f32 v109, v109
    v_exp_f32 v110, v110
    v_cvt_pk_bf16_f32 v56, v108, v109
    v_exp_f32 v111, v111
    s_waitcnt lgkmcnt(4)
    v_mfma_f32_32x32x16_bf16 v[132:147], v[44:47], v[52:55], v[132:147]
    v_exp_f32 v112, v112
    v_cvt_pk_bf16_f32 v57, v110, v111
    v_exp_f32 v113, v113
    v_exp_f32 v114, v114
    v_cvt_pk_bf16_f32 v58, v112, v113
    v_exp_f32 v115, v115
    v_mfma_f32_32x32x8_bf16 v[68:83], v[40:41], v[36:37], v[68:83]
    v_exp_f32 v116, v116
    v_cvt_pk_bf16_f32 v59, v114, v115
    v_exp_f32 v117, v117
    v_exp_f32 v118, v118
    v_cvt_pk_bf16_f32 v60, v116, v117
    v_exp_f32 v119, v119
    s_waitcnt lgkmcnt(2)
    v_mfma_f32_32x32x16_bf16 v[132:147], v[48:51], v[56:59], v[132:147]
    v_exp_f32 v120, v120
    v_cvt_pk_bf16_f32 v61, v118, v119
    v_exp_f32 v121, v121
    v_exp_f32 v122, v122
    v_cvt_pk_bf16_f32 v62, v120, v121
    v_exp_f32 v123, v123
    v_mfma_f32_32x32x8_bf16 v[84:99], v[40:41], v[38:39], v[84:99]
    ds_read_b64 v[40:41], v5 offset:26112
    v_exp_f32 v124, v124
    v_cvt_pk_bf16_f32 v63, v122, v123
    v_exp_f32 v125, v125
    v_exp_f32 v126, v126
    v_cvt_pk_bf16_f32 v64, v124, v125
    v_exp_f32 v127, v127
    v_mfma_f32_32x32x16_bf16 v[148:163], v[44:47], v[60:63], v[148:163]
    ds_read_b64_tr_b16 v[44:45], v6 offset:25856
    ds_read_b64_tr_b16 v[46:47], v6 offset:25920
    v_exp_f32 v128, v128
    v_cvt_pk_bf16_f32 v65, v126, v127
    v_exp_f32 v129, v129
    v_exp_f32 v130, v130
    v_cvt_pk_bf16_f32 v66, v128, v129
    v_exp_f32 v131, v131
    s_waitcnt lgkmcnt(3)
    v_mfma_f32_32x32x16_bf16 v[100:115], v[32:35], v[24:27], 0
    v_exp_f32 v68, v68
    v_cvt_pk_bf16_f32 v67, v130, v131
    v_exp_f32 v69, v69
    v_exp_f32 v70, v70
    v_cvt_pk_bf16_f32 v52, v68, v69
    v_exp_f32 v71, v71
    v_mfma_f32_32x32x16_bf16 v[148:163], v[48:51], v[64:67], v[148:163]
    ds_read_b64_tr_b16 v[48:49], v6 offset:25984
    ds_read_b64_tr_b16 v[50:51], v6 offset:26048
    v_exp_f32 v72, v72
    v_cvt_pk_bf16_f32 v53, v70, v71
    v_exp_f32 v73, v73
    v_exp_f32 v74, v74
    v_cvt_pk_bf16_f32 v54, v72, v73
    v_exp_f32 v75, v75
    v_mfma_f32_32x32x16_bf16 v[116:131], v[32:35], v[28:31], 0
    s_waitcnt vmcnt(0)
    s_barrier
    v_add_u32 v4, s30, v4
    v_add_u32 v5, s30, v5
    ds_read_b64 v[32:33], v4 offset:0
    ds_read_b64 v[34:35], v4 offset:1056
    s_cmp_eq_u32 s19, 3
    s_cbranch_scc1 L_nd_60
    s_add_u32 s14, s27, s13
    s_add_u32 m0, s14, 25344
    s_add_u32 s24, s24, 1024
    s_sub_u32 s14, s24, 1024
    buffer_load_dwordx4 v17, s[4:7], s14 offen lds
L_nd_60:
    v_exp_f32 v76, v76
    v_cvt_pk_bf16_f32 v55, v74, v75
    v_exp_f32 v77, v77
    v_exp_f32 v78, v78
    v_cvt_pk_bf16_f32 v56, v76, v77
    v_exp_f32 v79, v79
    s_waitcnt lgkmcnt(4)
    v_mfma_f32_32x32x16_bf16 v[132:147], v[44:47], v[52:55], v[132:147]
    v_exp_f32 v80, v80
    v_cvt_pk_bf16_f32 v57, v78, v79
    v_exp_f32 v81, v81
    v_exp_f32 v82, v82
    v_cvt_pk_bf16_f32 v58, v80, v81
    v_exp_f32 v83, v83
    v_mfma_f32_32x32x8_bf16 v[100:115], v[40:41], v[36:37], v[100:115]
    v_exp_f32 v84, v84
    v_cvt_pk_bf16_f32 v59, v82, v83
    v_exp_f32 v85, v85
    v_exp_f32 v86, v86
    v_cvt_pk_bf16_f32 v60, v84, v85
    v_exp_f32 v87, v87
    s_waitcnt lgkmcnt(2)
    v_mfma_f32_32x32x16_bf16 v[132:147], v[48:51], v[56:59], v[132:147]
    v_exp_f32 v88, v88
    v_cvt_pk_bf16_f32 v61, v86, v87
    v_exp_f32 v89, v89
    v_exp_f32 v90, v90
    v_cvt_pk_bf16_f32 v62, v88, v89
    v_exp_f32 v91, v91
    v_mfma_f32_32x32x8_bf16 v[116:131], v[40:41], v[38:39], v[116:131]
    ds_read_b64 v[40:41], v5 offset:0
    v_exp_f32 v92, v92
    v_cvt_pk_bf16_f32 v63, v90, v91
    v_exp_f32 v93, v93
    v_exp_f32 v94, v94
    v_cvt_pk_bf16_f32 v64, v92, v93
    v_exp_f32 v95, v95
    v_mfma_f32_32x32x16_bf16 v[148:163], v[44:47], v[60:63], v[148:163]
    ds_read_b64_tr_b16 v[44:45], v6 offset:26112
    ds_read_b64_tr_b16 v[46:47], v6 offset:26176
    v_exp_f32 v96, v96
    v_cvt_pk_bf16_f32 v65, v94, v95
    v_exp_f32 v97, v97
    v_exp_f32 v98, v98
    v_cvt_pk_bf16_f32 v66, v96, v97
    v_exp_f32 v99, v99
    s_waitcnt lgkmcnt(3)
    v_mfma_f32_32x32x16_bf16 v[68:83], v[32:35], v[24:27], 0
    v_exp_f32 v100, v100
    v_cvt_pk_bf16_f32 v67, v98, v99
    v_exp_f32 v101, v101
    v_exp_f32 v102, v102
    v_cvt_pk_bf16_f32 v52, v100, v101
    v_exp_f32 v103, v103
    v_mfma_f32_32x32x16_bf16 v[148:163], v[48:51], v[64:67], v[148:163]
    ds_read_b64_tr_b16 v[48:49], v6 offset:26240
    ds_read_b64_tr_b16 v[50:51], v6 offset:26304
    v_exp_f32 v104, v104
    v_cvt_pk_bf16_f32 v53, v102, v103
    v_exp_f32 v105, v105
    v_exp_f32 v106, v106
    v_cvt_pk_bf16_f32 v54, v104, v105
    v_exp_f32 v107, v107
    v_mfma_f32_32x32x16_bf16 v[84:99], v[32:35], v[28:31], 0
    ds_read_b64 v[32:33], v4 offset:256
    ds_read_b64 v[34:35], v4 offset:1312
    s_cmp_eq_u32 s19, 3
    s_cbranch_scc1 L_weB
L_weB_ret:
    s_cmp_eq_u32 s19, 3
    s_cbranch_scc1 L_nd_61
    s_add_u32 s14, s28, s13
    s_add_u32 m0, s14, 25344
    s_add_u32 s25, s25, 1024
    s_sub_u32 s14, s25, 1024
    buffer_load_dwordx4 v17, s[4:7], s14 offen lds
L_nd_61:
    v_exp_f32 v108, v108
    v_cvt_pk_bf16_f32 v55, v106, v107
    v_exp_f32 v109, v109
    v_exp_f32 v110, v110
    v_cvt_pk_bf16_f32 v56, v108, v109
    v_exp_f32 v111, v111
    s_waitcnt lgkmcnt(4)
    v_mfma_f32_32x32x16_bf16 v[132:147], v[44:47], v[52:55], v[132:147]
    v_exp_f32 v112, v112
    v_cvt_pk_bf16_f32 v57, v110, v111
    v_exp_f32 v113, v113
    v_exp_f32 v114, v114
    v_cvt_pk_bf16_f32 v58, v112, v113
    v_exp_f32 v115, v115
    v_mfma_f32_32x32x8_bf16 v[68:83], v[40:41], v[36:37], v[68:83]
    v_exp_f32 v116, v116
    v_cvt_pk_bf16_f32 v59, v114, v115
    v_exp_f32 v117, v117
    v_exp_f32 v118, v118
    v_cvt_pk_bf16_f32 v60, v116, v117
    v_exp_f32 v119, v119
    s_waitcnt lgkmcnt(2)
    v_mfma_f32_32x32x16_bf16 v[132:147], v[48:51], v[56:59], v[132:147]
    v_exp_f32 v120, v120
    v_cvt_pk_bf16_f32 v61, v118, v119
    v_exp_f32 v121, v121
    v_exp_f32 v122, v122
    v_cvt_pk_bf16_f32 v62, v120, v121
    v_exp_f32 v123, v123
    v_mfma_f32_32x32x8_bf16 v[84:99], v[40:41], v[38:39], v[84:99]
    ds_read_b64 v[40:41], v5 offset:256
    v_add_u32 v6, s30, v6
    v_exp_f32 v124, v124
    v_cvt_pk_bf16_f32 v63, v122, v123
    v_exp_f32 v125, v125
    v_exp_f32 v126, v126
    v_cvt_pk_bf16_f32 v64, v124, v125
    v_exp_f32 v127, v127
    v_mfma_f32_32x32x16_bf16 v[148:163], v[44:47], v[60:63], v[148:163]
    ds_read_b64_tr_b16 v[44:45], v6 offset:0
    ds_read_b64_tr_b16 v[46:47], v6 offset:64
    v_exp_f32 v128, v128
    v_cvt_pk_bf16_f32 v65, v126, v127
    v_exp_f32 v129, v129
    v_exp_f32 v130, v130
    v_cvt_pk_bf16_f32 v66, v128, v129
    v_exp_f32 v131, v131
    s_sub_u32 s30, 0, s30
    s_mov_b32 s14, s32
    s_mov_b32 s32, s13
    s_mov_b32 s13, s14
    s_add_u32 s19, s19, 1
    s_cmp_lt_u32 s19, 4
    s_cbranch_scc1 L_attn_loopB
    s_branch L_attn_loopdone
L_attn_slow:
    s_xor_b32 s14, s8, 4
    s_mul_i32 s14, s14, 3072
    s_add_u32 s13, s14, 102400
    v_and_b32 v21, 31, v1
    v_lshlrev_b32 v21, 3, v21
    v_lshrrev_b32 v22, 5, v1
    v_lshl_add_u32 v4, v22, 9, v21
    v_add_u32 v4, s13, v4
    v_add_u32 v5, 1024, v21
    v_add_u32 v5, s13, v5
    v_lshlrev_b32 v22, 2, v22
    v_bfe_u32 v23, v1, 2, 2
    v_add_u32 v22, v22, v23
    v_lshlrev_b32 v6, 3, v22
    v_and_b32 v22, 3, v1
    v_and_b32 v23, 1, v1
    v_add_u32 v23, 4, v23
    v_bfe_u32 v19, v1, 4, 1
    v_cmp_eq_u32 vcc, 1, v19
    s_nop 1
    v_cndmask_b32 v22, v22, v23, vcc
    v_lshl_add_u32 v6, v22, 8, v6
    v_add_u32 v6, 1280, v6
    v_add_u32 v6, s13, v6
    v_lshrrev_b32 v22, 4, v1
    v_lshlrev_b32 v22, 14, v22
    v_and_b32 v23, 15, v1
    v_lshl_add_u32 v7, v23, 4, v22
    v_mov_b32 v44, 0x3f80
    v_mov_b32 v45, 0
    v_lshlrev_b32 v22, 3, v1
    v_add_u32 v22, s13, v22
    v_cmp_gt_u32 vcc, 32, v1
    s_and_saveexec_b64 s[20:21], vcc
    ds_write_b64 v22, v[44:45] offset:2560
    s_mov_b64 exec, s[20:21]
    v_mov_b32 v21, 0xff800000
    s_mov_b32 s32, 0
    s_mov_b32 s19, 0
L_attn_maxpass:
    s_add_u32 m0, s13, 0
    s_add_u32 s14, s31, s32
    s_add_u32 s14, s14, 2621440
    buffer_load_dwordx4 v7, s[4:7], s14 offen lds
    s_add_u32 m0, s13, 1280
    s_add_u32 s15, s14, 2621440
    buffer_load_dwordx4 v7, s[4:7], s15 offen lds
    s_mov_b64 s[20:21], exec
    s_mov_b64 exec, 0xffff
    s_add_u32 m0, s13, 1024
    s_add_u32 s14, s14, 65536
    buffer_load_dwordx4 v7, s[4:7], s14 offen lds
    s_add_u32 m0, s13, 2304
    s_add_u32 s15, s15, 65536
    buffer_load_dwordx4 v7, s[4:7], s15 offen lds
    s_mov_b64 exec, s[20:21]
    s_add_u32 s32, s32, 256
    s_waitcnt vmcnt(0) lgkmcnt(0)
    ds_read_b64 v[32:33], v4
    ds_read_b64 v[34:35], v4 offset:256
    ds_read_b64 v[40:41], v5
    s_waitcnt lgkmcnt(0)
    v_mfma_f32_32x32x16_bf16 v[116:131], v[32:35], v[24:27], 0
    v_mfma_f32_32x32x8_bf16 v[116:131], v[40:41], v[36:37], v[116:131]
    s_nop 15
    v_max3_f32 v21, v116, v117, v21
    v_max3_f32 v21, v118, v119, v21
    v_max3_f32 v21, v120, v121, v21
    v_max3_f32 v21, v122, v123, v21
    v_max3_f32 v21, v124, v125, v21
    v_max3_f32 v21, v126, v127, v21
    v_max3_f32 v21, v128, v129, v21
    v_max3_f32 v21, v130, v131, v21
    s_add_u32 s19, s19, 1
    s_cmp_lt_u32 s19, 64
    s_cbranch_scc1 L_attn_maxpass
    v_mov_b32 v19, v21
    s_nop 1
    v_permlane32_swap_b32 v19, v21
    s_nop 1
    v_max_f32 v21, v21, v19
    s_mov_b32 s32, 0
    s_mov_b32 s19, 0
    v_sub_f32 v100, 0, v21
    v_mov_b32 v84, 0
    v_sub_f32 v101, 0, v21
    v_mov_b32 v85, 0
    v_sub_f32 v102, 0, v21
    v_mov_b32 v86, 0
    v_sub_f32 v103, 0, v21
    v_mov_b32 v87, 0
    v_sub_f32 v104, 0, v21
    v_mov_b32 v88, 0
    v_sub_f32 v105, 0, v21
    v_mov_b32 v89, 0
    v_sub_f32 v106, 0, v21
    v_mov_b32 v90, 0
    v_sub_f32 v107, 0, v21
    v_mov_b32 v91, 0
    v_sub_f32 v108, 0, v21
    v_mov_b32 v92, 0
    v_sub_f32 v109, 0, v21
    v_mov_b32 v93, 0
    v_sub_f32 v110, 0, v21
    v_mov_b32 v94, 0
    v_sub_f32 v111, 0, v21
    v_mov_b32 v95, 0
    v_sub_f32 v112, 0, v21
    v_mov_b32 v96, 0
    v_sub_f32 v113, 0, v21
    v_mov_b32 v97, 0
    v_sub_f32 v114, 0, v21
    v_mov_b32 v98, 0
    v_sub_f32 v115, 0, v21
    v_mov_b32 v99, 0
L_attn_slow2:
    s_add_u32 m0, s13, 0
    s_add_u32 s14, s31, s32
    s_add_u32 s14, s14, 2621440
    buffer_load_dwordx4 v7, s[4:7], s14 offen lds
    s_add_u32 m0, s13, 1280
    s_add_u32 s15, s14, 2621440
    buffer_load_dwordx4 v7, s[4:7], s15 offen lds
    s_mov_b64 s[20:21], exec
    s_mov_b64 exec, 0xffff
    s_add_u32 m0, s13, 1024
    s_add_u32 s14, s14, 65536
    buffer_load_dwordx4 v7, s[4:7], s14 offen lds
    s_add_u32 m0, s13, 2304
    s_add_u32 s15, s15, 65536
    buffer_load_dwordx4 v7, s[4:7], s15 offen lds
    s_mov_b64 exec, s[20:21]
    s_add_u32 s32, s32, 256
    s_waitcnt vmcnt(0) lgkmcnt(0)
    ds_read_b64 v[32:33], v4
    ds_read_b64 v[34:35], v4 offset:256
    ds_read_b64 v[40:41], v5
    ds_read_b64_tr_b16 v[44:45], v6 offset:0
    ds_read_b64_tr_b16 v[46:47], v6 offset:64
    ds_read_b64_tr_b16 v[48:49], v6 offset:128
    ds_read_b64_tr_b16 v[50:51], v6 offset:192
    s_waitcnt lgkmcnt(0)
    v_mfma_f32_32x32x16_bf16 v[116:131], v[32:35], v[24:27], v[100:115]
    v_mfma_f32_32x32x8_bf16 v[116:131], v[40:41], v[36:37], v[116:131]
    s_nop 15
    v_exp_f32 v116, v116
    v_exp_f32 v117, v117
    v_exp_f32 v118, v118
    v_exp_f32 v119, v119
    v_exp_f32 v120, v120
    v_exp_f32 v121, v121
    v_exp_f32 v122, v122
    v_exp_f32 v123, v123
    v_exp_f32 v124, v124
    v_exp_f32 v125, v125
    v_exp_f32 v126, v126
    v_exp_f32 v127, v127
    v_exp_f32 v128, v128
    v_exp_f32 v129, v129
    v_exp_f32 v130, v130
    v_exp_f32 v131, v131
    s_nop 0
    v_cvt_pk_bf16_f32 v52, v116, v117
    v_cvt_pk_bf16_f32 v53, v118, v119
    v_cvt_pk_bf16_f32 v54, v120, v121
    v_cvt_pk_bf16_f32 v55, v122, v123
    v_cvt_pk_bf16_f32 v56, v124, v125
    v_cvt_pk_bf16_f32 v57, v126, v127
    v_cvt_pk_bf16_f32 v58, v128, v129
    v_cvt_pk_bf16_f32 v59, v130, v131
    s_nop 1
    v_mfma_f32_32x32x16_bf16 v[84:99], v[44:47], v[52:55], v[84:99]
    v_mfma_f32_32x32x16_bf16 v[84:99], v[48:51], v[56:59], v[84:99]
    s_add_u32 s19, s19, 1
    s_cmp_lt_u32 s19, 64
    s_cbranch_scc1 L_attn_slow2
    s_nop 15
    v_mov_b32 v19, v92
    v_mov_b32 v18, v92
    s_nop 1
    v_permlane32_swap_b32 v19, v18
    s_branch L_attn_fin
L_wnok_63:
    s_mov_b32 s92, 0
    s_mov_b32 s93, 50331648
L_wcnt_64:
    buffer_load_dword v3, v12, s[4:7], s93 offen sc1
    s_add_u32 s92, s92, 1
    s_waitcnt vmcnt(0)
    v_cmp_le_u32 vcc, v13, v3
    s_nop 1
    s_cmp_eq_u64 vcc, exec
    s_cbranch_scc1 L_wcntd_65
    s_sleep 3
    s_cmp_lt_u32 s92, 131072
    s_cbranch_scc1 L_wcnt_64
L_wcntd_65:
    s_branch L_wok_62
L_weA:
    v_cmp_le_u32 vcc, v13, v11
    s_nop 1
    s_cmp_eq_u64 vcc, exec
    s_cbranch_scc0 L_weA_ret
    s_mov_b32 s57, 1
    s_lshr_b32 s36, s2, 5
    s_mul_i32 s36, s36, 102400
    s_add_u32 s36, s36, 22020096
    s_add_u32 s37, s8, 0
    s_lshl_b32 s61, s37, 10
    s_mov_b32 m0, s61
    s_add_u32 s61, s61, s36
    buffer_load_dwordx4 v17, s[4:7], s61 offen lds
    s_add_u32 s37, s8, 8
    s_lshl_b32 s61, s37, 10
    s_mov_b32 m0, s61
    s_add_u32 s61, s61, s36
    buffer_load_dwordx4 v17, s[4:7], s61 offen lds
    s_add_u32 s37, s8, 16
    s_lshl_b32 s61, s37, 10
    s_mov_b32 m0, s61
    s_add_u32 s61, s61, s36
    buffer_load_dwordx4 v17, s[4:7], s61 offen lds
    s_add_u32 s37, s8, 24
    s_lshl_b32 s61, s37, 10
    s_mov_b32 m0, s61
    s_add_u32 s61, s61, s36
    buffer_load_dwordx4 v17, s[4:7], s61 offen lds
    s_add_u32 s37, s8, 32
    s_lshl_b32 s61, s37, 10
    s_mov_b32 m0, s61
    s_add_u32 s61, s61, s36
    buffer_load_dwordx4 v17, s[4:7], s61 offen lds
    s_add_u32 s37, s8, 40
    s_lshl_b32 s61, s37, 10
    s_mov_b32 m0, s61
    s_add_u32 s61, s61, s36
    buffer_load_dwordx4 v17, s[4:7], s61 offen lds
    s_add_u32 s37, s8, 48
    s_lshl_b32 s61, s37, 10
    s_mov_b32 m0, s61
    s_add_u32 s61, s61, s36
    buffer_load_dwordx4 v17, s[4:7], s61 offen lds
    s_add_u32 s37, s8, 56
    s_lshl_b32 s61, s37, 10
    s_mov_b32 m0, s61
    s_add_u32 s61, s61, s36
    buffer_load_dwordx4 v17, s[4:7], s61 offen lds
    s_add_u32 s37, s8, 64
    s_lshl_b32 s61, s37, 10
    s_mov_b32 m0, s61
    s_add_u32 s61, s61, s36
    buffer_load_dwordx4 v17, s[4:7], s61 offen lds
    s_add_u32 s37, s8, 72
    s_lshl_b32 s61, s37, 10
    s_cmp_ge_u32 s37, 74
    s_cselect_b32 s37, 51200, 0
    s_add_u32 m0, s61, s37
    s_add_u32 s61, s61, s36
    buffer_load_dwordx4 v17, s[4:7], s61 offen lds
    s_add_u32 s37, s8, 80
    s_lshl_b32 s61, s37, 10
    s_add_u32 m0, s61, 51200
    s_add_u32 s61, s61, s36
    buffer_load_dwordx4 v17, s[4:7], s61 offen lds
    s_add_u32 s37, s8, 88
    s_lshl_b32 s61, s37, 10
    s_add_u32 m0, s61, 51200
    s_add_u32 s61, s61, s36
    buffer_load_dwordx4 v17, s[4:7], s61 offen lds
    s_add_u32 s37, s8, 96
    s_min_u32 s37, s37, 99
    s_lshl_b32 s61, s37, 10
    s_add_u32 m0, s61, 51200
    s_add_u32 s61, s61, s36
    buffer_load_dwordx4 v17, s[4:7], s61 offen lds
    s_branch L_weA_ret
L_weB:
    v_cmp_le_u32 vcc, v13, v11
    s_nop 1
    s_cmp_eq_u64 vcc, exec
    s_cbranch_scc0 L_weB_ret
    s_mov_b32 s57, 1
    s_lshr_b32 s36, s2, 5
    s_mul_i32 s36, s36, 102400
    s_add_u32 s36, s36, 22020096
    s_add_u32 s37, s8, 0
    s_lshl_b32 s61, s37, 10
    s_mov_b32 m0, s61
    s_add_u32 s61, s61, s36
    buffer_load_dwordx4 v17, s[4:7], s61 offen lds
    s_add_u32 s37, s8, 8
    s_lshl_b32 s61, s37, 10
    s_mov_b32 m0, s61
    s_add_u32 s61, s61, s36
    buffer_load_dwordx4 v17, s[4:7], s61 offen lds
    s_add_u32 s37, s8, 16
    s_lshl_b32 s61, s37, 10
    s_mov_b32 m0, s61
    s_add_u32 s61, s61, s36
    buffer_load_dwordx4 v17, s[4:7], s61 offen lds
    s_add_u32 s37, s8, 24
    s_lshl_b32 s61, s37, 10
    s_mov_b32 m0, s61
    s_add_u32 s61, s61, s36
    buffer_load_dwordx4 v17, s[4:7], s61 offen lds
    s_add_u32 s37, s8, 32
    s_lshl_b32 s61, s37, 10
    s_mov_b32 m0, s61
    s_add_u32 s61, s61, s36
    buffer_load_dwordx4 v17, s[4:7], s61 offen lds
    s_add_u32 s37, s8, 40
    s_lshl_b32 s61, s37, 10
    s_mov_b32 m0, s61
    s_add_u32 s61, s61, s36
    buffer_load_dwordx4 v17, s[4:7], s61 offen lds
    s_add_u32 s37, s8, 48
    s_lshl_b32 s61, s37, 10
    s_mov_b32 m0, s61
    s_add_u32 s61, s61, s36
    buffer_load_dwordx4 v17, s[4:7], s61 offen lds
    s_add_u32 s37, s8, 56
    s_lshl_b32 s61, s37, 10
    s_mov_b32 m0, s61
    s_add_u32 s61, s61, s36
    buffer_load_dwordx4 v17, s[4:7], s61 offen lds
    s_add_u32 s37, s8, 64
    s_lshl_b32 s61, s37, 10
    s_mov_b32 m0, s61
    s_add_u32 s61, s61, s36
    buffer_load_dwordx4 v17, s[4:7], s61 offen lds
    s_add_u32 s37, s8, 72
    s_lshl_b32 s61, s37, 10
    s_cmp_ge_u32 s37, 74
    s_cselect_b32 s37, 51200, 0
    s_add_u32 m0, s61, s37
    s_add_u32 s61, s61, s36
    buffer_load_dwordx4 v17, s[4:7], s61 offen lds
    s_add_u32 s37, s8, 80
    s_lshl_b32 s61, s37, 10
    s_add_u32 m0, s61, 51200
    s_add_u32 s61, s61, s36
    buffer_load_dwordx4 v17, s[4:7], s61 offen lds
    s_add_u32 s37, s8, 88
    s_lshl_b32 s61, s37, 10
    s_add_u32 m0, s61, 51200
    s_add_u32 s61, s61, s36
    buffer_load_dwordx4 v17, s[4:7], s61 offen lds
    s_add_u32 s37, s8, 96
    s_min_u32 s37, s37, 99
    s_lshl_b32 s61, s37, 10
    s_add_u32 m0, s61, 51200
    s_add_u32 s61, s61, s36
    buffer_load_dwordx4 v17, s[4:7], s61 offen lds
    s_branch L_weB_ret
L_wl_66:
    s_lshr_b32 s36, s2, 5
    s_mul_i32 s36, s36, 102400
    s_add_u32 s36, s36, 22020096
    s_add_u32 s37, s8, 0
    s_lshl_b32 s61, s37, 10
    s_mov_b32 m0, s61
    s_add_u32 s61, s61, s36
    buffer_load_dwordx4 v17, s[4:7], s61 offen lds
    s_add_u32 s37, s8, 8
    s_lshl_b32 s61, s37, 10
    s_mov_b32 m0, s61
    s_add_u32 s61, s61, s36
    buffer_load_dwordx4 v17, s[4:7], s61 offen lds
    s_add_u32 s37, s8, 16
    s_lshl_b32 s61, s37, 10
    s_mov_b32 m0, s61
    s_add_u32 s61, s61, s36
    buffer_load_dwordx4 v17, s[4:7], s61 offen lds
    s_add_u32 s37, s8, 24
    s_lshl_b32 s61, s37, 10
    s_mov_b32 m0, s61
    s_add_u32 s61, s61, s36
    buffer_load_dwordx4 v17, s[4:7], s61 offen lds
    s_add_u32 s37, s8, 32
    s_lshl_b32 s61, s37, 10
    s_mov_b32 m0, s61
    s_add_u32 s61, s61, s36
    buffer_load_dwordx4 v17, s[4:7], s61 offen lds
    s_add_u32 s37, s8, 40
    s_lshl_b32 s61, s37, 10
    s_mov_b32 m0, s61
    s_add_u32 s61, s61, s36
    buffer_load_dwordx4 v17, s[4:7], s61 offen lds
    s_add_u32 s37, s8, 48
    s_lshl_b32 s61, s37, 10
    s_mov_b32 m0, s61
    s_add_u32 s61, s61, s36
    buffer_load_dwordx4 v17, s[4:7], s61 offen lds
    s_add_u32 s37, s8, 56
    s_lshl_b32 s61, s37, 10
    s_mov_b32 m0, s61
    s_add_u32 s61, s61, s36
    buffer_load_dwordx4 v17, s[4:7], s61 offen lds
    s_add_u32 s37, s8, 64
    s_lshl_b32 s61, s37, 10
    s_mov_b32 m0, s61
    s_add_u32 s61, s61, s36
    buffer_load_dwordx4 v17, s[4:7], s61 offen lds
    s_add_u32 s37, s8, 72
    s_lshl_b32 s61, s37, 10
    s_cmp_ge_u32 s37, 74
    s_cselect_b32 s37, 51200, 0
    s_add_u32 m0, s61, s37
    s_add_u32 s61, s61, s36
    buffer_load_dwordx4 v17, s[4:7], s61 offen lds
    s_add_u32 s37, s8, 80
    s_lshl_b32 s61, s37, 10
    s_add_u32 m0, s61, 51200
    s_add_u32 s61, s61, s36
    buffer_load_dwordx4 v17, s[4:7], s61 offen lds
    s_add_u32 s37, s8, 88
    s_lshl_b32 s61, s37, 10
    s_add_u32 m0, s61, 51200
    s_add_u32 s61, s61, s36
    buffer_load_dwordx4 v17, s[4:7], s61 offen lds
    s_add_u32 s37, s8, 96
    s_min_u32 s37, s37, 99
    s_lshl_b32 s61, s37, 10
    s_add_u32 m0, s61, 51200
    s_add_u32 s61, s61, s36
    buffer_load_dwordx4 v17, s[4:7], s61 offen lds
    s_waitcnt vmcnt(0)
    s_branch L_wl2_67
L_tail_aux:
    v_mov_b32 v2, 163776
    v_mov_b32 v3, 1
    s_mov_b64 s[94:95], exec
    s_mov_b64 exec, 1
    ds_add_u32 v2, v3 offset:12
    s_mov_b64 exec, s[94:95]
    s_and_b32 s24, s2, 7
    s_lshl_b32 s24, s24, 2
    s_bfe_u32 s26, s2, 0x20003
    s_add_u32 s24, s24, s26
    s_lshr_b32 s25, s2, 5
    s_mov_b32 s20, s70
    s_and_b32 s21, s71, 0xffff
    s_mov_b32 s22, 2621440
    s_mov_b32 s23, 0x20000
    s_sub_u32 s28, s8, 4
    s_mul_i32 s30, s28, 5120
    s_add_u32 s30, s30, 76288
    s_lshl_b32 s26, s24, 6
    s_lshl_b32 s27, s28, 4
    s_add_u32 s29, s26, s27
    v_add_u32 v4, 0, v1
    v_mul_u32_u24 v5, 6554, v4
    v_lshrrev_b32 v5, 16, v5
    v_mul_u32_u24 v7, 10, v5
    v_sub_u32 v6, v4, v7
    v_add_u32 v5, s29, v5
    v_mul_u32_u24 v12, 1280, v5
    v_lshl_add_u32 v12, v6, 4, v12
    v_add_u32 v4, 64, v1
    v_mul_u32_u24 v5, 6554, v4
    v_lshrrev_b32 v5, 16, v5
    v_mul_u32_u24 v7, 10, v5
    v_sub_u32 v6, v4, v7
    v_add_u32 v5, s29, v5
    v_mul_u32_u24 v13, 1280, v5
    v_lshl_add_u32 v13, v6, 4, v13
    v_add_u32 v4, 128, v1
    v_mul_u32_u24 v5, 6554, v4
    v_lshrrev_b32 v5, 16, v5
    v_mul_u32_u24 v7, 10, v5
    v_sub_u32 v6, v4, v7
    v_add_u32 v5, s29, v5
    v_mul_u32_u24 v14, 1280, v5
    v_lshl_add_u32 v14, v6, 4, v14
    s_mul_i32 s26, s25, 160
    s_add_u32 m0, s30, 2560
    s_nop 0
    buffer_load_dwordx4 v12, s[20:23], s26 offen lds
    s_add_u32 m0, s30, 3584
    s_nop 0
    buffer_load_dwordx4 v13, s[20:23], s26 offen lds
    s_mov_b64 exec, 0xffffffff
    s_add_u32 m0, s30, 4608
    s_nop 0
    buffer_load_dwordx4 v14, s[20:23], s26 offen lds
    s_mov_b64 exec, -1
    s_branch L_p3_aux
L_ore_77:
    s_add_u32 s32, s32, 1
    s_cmp_lt_u32 s32, 131072
    s_cbranch_scc0 L_ook_76
    s_nop 7
    v_mov_b32 v152, 0
    v_mov_b32 v153, 0
    v_mov_b32 v154, 0
    v_mov_b32 v155, 0
    v_mov_b32 v156, 0
    v_mov_b32 v157, 0
    v_mov_b32 v158, 0
    v_mov_b32 v159, 0
    v_mov_b32 v160, 0
    v_mov_b32 v161, 0
    v_mov_b32 v162, 0
    v_mov_b32 v163, 0
    v_mov_b32 v164, 0
    v_mov_b32 v165, 0
    v_mov_b32 v166, 0
    v_mov_b32 v167, 0
    v_mov_b32 v168, 0
    v_mov_b32 v169, 0
    v_mov_b32 v170, 0
    v_mov_b32 v171, 0
    s_sleep 2
    s_branch L_p3_retry
L_p3_aux:
    s_mov_b32 s16, s82
    s_and_b32 s17, s83, 0xffff
    s_mov_b32 s18, 5242880
    s_mov_b32 s19, 0x20000
    s_add_u32 s26, s25, 24
    s_lshl_b32 s26, s26, 8
    v_mov_b32 v4, s26
    v_lshrrev_b32 v10, 1, v1
    v_lshlrev_b32 v10, 12, v10
    v_and_b32 v5, 1, v1
    v_lshl_add_u32 v10, v5, 4, v10
    s_cmp_eq_u32 s8, 7
    s_cbranch_scc0 L_pz_78
    s_mov_b32 s92, 0
    s_mov_b32 s93, 50331648
L_wcnt_80:
    buffer_load_dword v3, v4, s[4:7], s93 offen sc1
    s_add_u32 s92, s92, 1
    s_waitcnt vmcnt(0)
    v_cmp_le_u32 vcc, 80, v3
    s_nop 1
    s_cmp_eq_u64 vcc, exec
    s_cbranch_scc1 L_wcntd_81
    s_sleep 3
    s_cmp_lt_u32 s92, 131072
    s_cbranch_scc1 L_wcnt_80
L_wcntd_81:
    v_mov_b32 v2, 163776
    v_mov_b32 v3, 1
    ds_write_b32 v2, v3 offset:8
    s_branch L_pz2_79
L_pz_78:
    v_mov_b32 v2, 163776
    s_mov_b32 s92, 0
L_lw_82:
    ds_read_b32 v3, v2 offset:8
    s_add_u32 s92, s92, 1
    s_waitcnt lgkmcnt(0)
    v_readfirstlane_b32 s93, v3
    s_cmp_lg_u32 s93, 0
    s_cbranch_scc1 L_lwd_83
    s_sleep 1
    s_cmp_lt_u32 s92, 2097152
    s_cbranch_scc1 L_lw_82
L_lwd_83:
L_pz2_79:
    s_mul_i32 s26, s25, 327680
    s_lshl_b32 s27, s29, 1
    s_add_u32 s26, s26, s27
    s_add_u32 s26, s26, 18874368
    s_add_u32 m0, s30, 0
    s_add_u32 s27, s26, 0
    buffer_load_dwordx4 v10, s[4:7], s27 offen lds
    s_add_u32 m0, s30, 1024
    s_add_u32 s27, s26, 131072
    buffer_load_dwordx4 v10, s[4:7], s27 offen lds
    s_mov_b64 exec, 0xffffffff
    s_add_u32 m0, s30, 2048
    s_add_u32 s27, s26, 262144
    buffer_load_dwordx4 v10, s[4:7], s27 offen lds
    s_mov_b64 exec, -1
    v_lshrrev_b32 v67, 4, v1
    v_lshlrev_b32 v5, 3, v67
    v_bfe_u32 v6, v1, 2, 2
    v_add_u32 v5, v5, v6
    v_lshlrev_b32 v64, 5, v5
    v_and_b32 v6, 3, v1
    v_lshl_add_u32 v64, v6, 3, v64
    v_add_u32 v64, s30, v64
    v_and_b32 v5, 15, v1
    v_mul_u32_u24 v65, 160, v5
    v_lshl_add_u32 v65, v67, 4, v65
    v_add_u32 v65, s30, v65
    v_add_u32 v5, s29, v5
    v_mul_u32_u24 v66, 2560, v5
    v_lshl_add_u32 v66, v67, 4, v66
    s_mul_i32 s26, s25, 160
    s_add_u32 s26, s26, 1280
    s_waitcnt vmcnt(0)
    ds_read_b64_tr_b16 v[20:21], v64 offset:0
    ds_read_b64_tr_b16 v[22:23], v64 offset:128
    ds_read_b128 v[32:35], v65 offset:2560
    ds_read_b64_tr_b16 v[24:25], v64 offset:1024
    ds_read_b64_tr_b16 v[26:27], v64 offset:1152
    ds_read_b128 v[36:39], v65 offset:2624
    ds_read_b64_tr_b16 v[28:29], v64 offset:2048
    ds_read_b64_tr_b16 v[30:31], v64 offset:2176
    ds_read_b128 v[40:43], v65 offset:2688
    s_waitcnt lgkmcnt(6)
    v_lshlrev_b32 v44, 16, v20
    v_and_b32 v45, 0xffff0000, v20
    v_lshlrev_b32 v52, 16, v32
    v_and_b32 v53, 0xffff0000, v32
    v_lshlrev_b32 v46, 16, v21
    v_and_b32 v47, 0xffff0000, v21
    v_lshlrev_b32 v54, 16, v33
    v_and_b32 v55, 0xffff0000, v33
    v_lshlrev_b32 v48, 16, v22
    v_and_b32 v49, 0xffff0000, v22
    v_lshlrev_b32 v56, 16, v34
    v_and_b32 v57, 0xffff0000, v34
    v_lshlrev_b32 v50, 16, v23
    v_and_b32 v51, 0xffff0000, v23
    v_lshlrev_b32 v58, 16, v35
    v_and_b32 v59, 0xffff0000, v35
    v_mul_f32 v44, v44, v52
    v_mul_f32 v45, v45, v53
    v_mul_f32 v46, v46, v54
    v_mul_f32 v47, v47, v55
    v_mul_f32 v48, v48, v56
    v_mul_f32 v49, v49, v57
    v_mul_f32 v50, v50, v58
    v_mul_f32 v51, v51, v59
    v_cvt_pk_bf16_f32 v20, v44, v45
    v_cvt_pk_bf16_f32 v21, v46, v47
    v_cvt_pk_bf16_f32 v22, v48, v49
    v_cvt_pk_bf16_f32 v23, v50, v51
    buffer_store_dwordx4 v[20:23], v66, s[16:19], s26 offen offset:0
    s_waitcnt lgkmcnt(3)
    v_lshlrev_b32 v44, 16, v24
    v_and_b32 v45, 0xffff0000, v24
    v_lshlrev_b32 v52, 16, v36
    v_and_b32 v53, 0xffff0000, v36
    v_lshlrev_b32 v46, 16, v25
    v_and_b32 v47, 0xffff0000, v25
    v_lshlrev_b32 v54, 16, v37
    v_and_b32 v55, 0xffff0000, v37
    v_lshlrev_b32 v48, 16, v26
    v_and_b32 v49, 0xffff0000, v26
    v_lshlrev_b32 v56, 16, v38
    v_and_b32 v57, 0xffff0000, v38
    v_lshlrev_b32 v50, 16, v27
    v_and_b32 v51, 0xffff0000, v27
    v_lshlrev_b32 v58, 16, v39
    v_and_b32 v59, 0xffff0000, v39
    v_mul_f32 v44, v44, v52
    v_mul_f32 v45, v45, v53
    v_mul_f32 v46, v46, v54
    v_mul_f32 v47, v47, v55
    v_mul_f32 v48, v48, v56
    v_mul_f32 v49, v49, v57
    v_mul_f32 v50, v50, v58
    v_mul_f32 v51, v51, v59
    v_cvt_pk_bf16_f32 v24, v44, v45
    v_cvt_pk_bf16_f32 v25, v46, v47
    v_cvt_pk_bf16_f32 v26, v48, v49
    v_cvt_pk_bf16_f32 v27, v50, v51
    buffer_store_dwordx4 v[24:27], v66, s[16:19], s26 offen offset:64
    s_waitcnt lgkmcnt(0)
    v_lshlrev_b32 v44, 16, v28
    v_and_b32 v45, 0xffff0000, v28
    v_lshlrev_b32 v52, 16, v40
    v_and_b32 v53, 0xffff0000, v40
    v_lshlrev_b32 v46, 16, v29
    v_and_b32 v47, 0xffff0000, v29
    v_lshlrev_b32 v54, 16, v41
    v_and_b32 v55, 0xffff0000, v41
    v_lshlrev_b32 v48, 16, v30
    v_and_b32 v49, 0xffff0000, v30
    v_lshlrev_b32 v56, 16, v42
    v_and_b32 v57, 0xffff0000, v42
    v_lshlrev_b32 v50, 16, v31
    v_and_b32 v51, 0xffff0000, v31
    v_lshlrev_b32 v58, 16, v43
    v_and_b32 v59, 0xffff0000, v43
    v_mul_f32 v44, v44, v52
    v_mul_f32 v45, v45, v53
    v_mul_f32 v46, v46, v54
    v_mul_f32 v47, v47, v55
    v_mul_f32 v48, v48, v56
    v_mul_f32 v49, v49, v57
    v_mul_f32 v50, v50, v58
    v_mul_f32 v51, v51, v59
    v_cvt_pk_bf16_f32 v28, v44, v45
    v_cvt_pk_bf16_f32 v29, v46, v47
    v_cvt_pk_bf16_f32 v30, v48, v49
    v_cvt_pk_bf16_f32 v31, v50, v51
    s_mov_b64 exec, 0xffffffff
    buffer_store_dwordx4 v[28:31], v66, s[16:19], s26 offen offset:128
    s_mov_b64 exec, -1
    s_branch L_p3_end
    s_endpgm
L_code_end:
.section .rodata,"a"
.p2align 6
.amdhsa_kernel concat_heads__softmax_full_mha__ssm_conv_h3__prompt_kernel
  .amdhsa_next_free_vgpr 248
  .amdhsa_next_free_sgpr 96
  .amdhsa_accum_offset 248
  .amdhsa_group_segment_fixed_size 0
  .amdhsa_kernarg_size 96
  .amdhsa_user_sgpr_count 2
  .amdhsa_user_sgpr_kernarg_segment_ptr 1
  .amdhsa_system_sgpr_workgroup_id_x 1
  .amdhsa_float_denorm_mode_32 3
.end_amdhsa_kernel
.text
```
